```python
import torch

def _softmax(x, axis=-1):
    return torch.softmax(x, dim=axis)

def _gelu(x):
    return torch.nn.functional.gelu(x, approximate='tanh')

def _silu(x):
    return torch.nn.functional.silu(x)

def _sigmoid(x):
    return torch.sigmoid(x)

def _layernorm(x, axis=-1, eps=1e-05):
    m = x.mean(dim=axis, keepdim=True)
    v = x.var(dim=axis, keepdim=True, unbiased=False)
    return (x - m) / torch.sqrt(v + eps)

def _scatter_add(tgt, idx, src, axis=0):
    return tgt.clone().index_add_(axis, idx, src)

def _segment_sum(src, seg, n):
    out = torch.zeros((n,) + src.shape[1:], dtype=src.dtype)
    return out.index_add_(0, seg, src)

def _pad(x, pw):
    flat = tuple((v for pair in reversed(pw) for v in pair))
    return torch.nn.functional.pad(x, flat)
kernel_name = 'standalone__kv_cache_quant_pre_rope_vs_post_rope__prompt'

def setup_inputs():

    _w = lambda a: (lambda t: t.to(torch.bfloat16) if t.is_floating_point() else t)(torch.as_tensor(a))
    B, Sq, Skv = (1, 2048, 2048)
    H, Dh0 = (4, 128)
    G = 128 if 128 > 0 else Dh0
    G = max(2, G // 2 * 2)
    Dh = max(G, Dh0 // G * G)
    Skv = max(Skv, Sq)
    ng = Dh // G
    bits = 2 if 2 > 1 else 4
    bits = max(2, min(8, bits))
    qmax = (1 << bits) - 1
    half = Dh // 2
    inv = 1.0 / 10000.0 ** (torch.arange(half) / max(1, half))
    ang_k = torch.arange(Skv)[:, None] * inv[None, :]
    ang_q = torch.arange(Skv - Sq, Skv)[:, None] * inv[None, :]
    kc = torch.cat([torch.cos(ang_k), torch.cos(ang_k)], dim=-1)
    ks = torch.cat([torch.sin(ang_k), torch.sin(ang_k)], dim=-1)
    qc = torch.cat([torch.cos(ang_q), torch.cos(ang_q)], dim=-1)
    qs = torch.cat([torch.sin(ang_q), torch.sin(ang_q)], dim=-1)
    qk_i = torch.randint(0, qmax + 1, (B, H, Skv, Dh)).to(torch.int32)
    qv_i = torch.randint(0, qmax + 1, (B, H, Skv, Dh)).to(torch.int32)
    ksc = torch.abs((lambda *s: torch.randn(*s, dtype=torch.bfloat16) * 0.4)(B, H, Skv, ng)) * 0.1 + 0.01
    kzp = torch.full((B, H, Skv, ng), qmax / 2.0)
    vsc = torch.abs((lambda *s: torch.randn(*s, dtype=torch.bfloat16) * 0.4)(B, H, Skv, ng)) * 0.1 + 0.01
    vzp = torch.full((B, H, Skv, ng), qmax / 2.0)
    return {'q': _w((lambda *s: torch.randn(*s, dtype=torch.bfloat16) * 6.4)(B, H, Sq, Dh) * 0.5), 'qk': _w(qk_i), 'k_scales': _w(ksc), 'k_zeros': _w(kzp), 'qv': _w(qv_i), 'v_scales': _w(vsc), 'v_zeros': _w(vzp), 'q_cos': _w(qc), 'q_sin': _w(qs), 'k_cos': _w(kc), 'k_sin': _w(ks)}

def reference(q, qk, k_scales, k_zeros, qv, v_scales, v_zeros, q_cos, q_sin, k_cos, k_sin):
    B, H, Sq, Dh = q.shape
    ng = k_scales.shape[-1]
    G = Dh // ng
    half = Dh // 2
    ks = (lambda x, n, axis: torch.repeat_interleave(x, n, dim=axis))(k_scales, G, axis=-1)
    kz = (lambda x, n, axis: torch.repeat_interleave(x, n, dim=axis))(k_zeros, G, axis=-1)
    k = ((lambda x, dt: x.to(dt))(qk, q.dtype) - kz) * ks
    vs = (lambda x, n, axis: torch.repeat_interleave(x, n, dim=axis))(v_scales, G, axis=-1)
    vz = (lambda x, n, axis: torch.repeat_interleave(x, n, dim=axis))(v_zeros, G, axis=-1)
    v = ((lambda x, dt: x.to(dt))(qv, q.dtype) - vz) * vs
    k1 = k[..., :half].clone()
    k2 = k[..., half:].clone()
    krh = torch.concatenate([-k2, k1], axis=-1)
    kr = k * k_cos[None, None, :, :] + krh * k_sin[None, None, :, :]
    q1 = q[..., :half].clone()
    q2 = q[..., half:].clone()
    qrh = torch.concatenate([-q2, q1], axis=-1)
    qr = q * q_cos[None, None, :, :] + qrh * q_sin[None, None, :, :]
    logits = torch.einsum('bhqd,bhkd->bhqk', qr, kr) * float(Dh) ** (-0.5)
    attn = _softmax(logits, axis=-1)
    out = torch.einsum('bhqk,bhkd->bhqd', attn, v)
    return out
```

```asm
; @launch grid=(256,1,1) block=(256,1,1) lds=132096
.amdgcn_target "amdgcn-amd-amdhsa--gfx950"
.text
.globl standalone__kv_cache_quant_pre_rope_vs_post_rope__prompt_kernel
.p2align 8
.type standalone__kv_cache_quant_pre_rope_vs_post_rope__prompt_kernel,@function
standalone__kv_cache_quant_pre_rope_vs_post_rope__prompt_kernel:
  s_load_dwordx16 s[4:19], s[0:1], 0
  s_cmpk_ge_u32 s2, 0x100
  s_cbranch_scc1 LA_end
  s_load_dwordx8 s[20:27], s[0:1], 64
  s_load_dwordx4 s[52:55], s[0:1], 96
  s_memrealtime s[68:69]
  s_getpc_b64 s[60:61]
  v_lshlrev_b32 v1, 6, v0
  global_load_dword a8, v1, s[60:61] offset:192
  s_and_b32 s41, s2, 7
  s_lshr_b32 s50, s2, 3
  s_lshl_b32 s48, s41, 5
  s_add_u32 s48, s48, s50
  s_lshl_b32 s59, s48, 14
  s_lshl_b32 s50, s41, 11
  v_lshrrev_b32 v158, 3, v0
  v_lshl_add_u32 v157, v0, 3, s50
  v_lshl_add_u32 v152, v0, 5, s59
  v_lshl_add_u32 v152, v158, 8, v152
  s_waitcnt lgkmcnt(0)
  global_load_dwordx2 v[112:113], v157, s[14:15] offset:0
  global_load_dwordx2 v[114:115], v157, s[16:17] offset:0
  s_barrier
  global_load_dwordx4 v[16:19], v152, s[6:7] offset:0
  global_load_dwordx4 v[20:23], v152, s[6:7] offset:16
  global_load_dwordx4 v[24:27], v152, s[6:7] offset:256
  global_load_dwordx4 v[28:31], v152, s[6:7] offset:272
  v_lshrrev_b32 v1, 6, v0
  v_and_b32 v174, 63, v0
  v_readfirstlane_b32 s40, v1
  v_lshlrev_b32 v1, 4, v174
  s_lshl_b32 s50, s48, 6
  v_lshl_add_u32 v154, v158, 1, s50
  v_mov_b32 v116, 0
  v_mov_b32 v117, 0
  s_lshl_b32 s50, s40, 11
  s_add_u32 s50, s50, s59
  v_lshrrev_b32 v170, 5, v174
  v_and_b32 v153, 0x1f0, v1
  v_lshl_add_u32 v153, v170, 13, v153
  v_add_u32 v153, s50, v153
  v_lshrrev_b32 v155, 1, v152
  v_xor_b32 v156, 0x40000, v155
  global_load_short_d16_hi v116, v154, s[8:9]
  global_load_short_d16_hi v117, v154, s[10:11]
  s_barrier
  global_load_dwordx4 v[80:83], v153, s[12:13] offset:0
  global_load_dwordx4 v[84:87], v153, s[12:13] offset:512
  global_load_dwordx4 v[88:91], v153, s[12:13] offset:1024
  global_load_dwordx4 v[92:95], v153, s[12:13] offset:1536
  s_barrier
  global_load_dwordx4 v[96:99], v155, s[4:5] offset:0
  global_load_dwordx4 v[100:103], v155, s[4:5] offset:128
  v_and_b32 v159, 7, v0
  v_lshrrev_b32 v160, 4, v174
  v_mov_b32 v119, 0
  s_and_b32 s46, s48, 7
  s_xor_b32 s46, s46, 7
  s_lshr_b32 s42, s41, 1
LA_notag:
  s_cmp_ge_u32 s2, 8
  s_cbranch_scc1 LA_offered
  s_cmp_lg_u32 s40, 0
  s_cbranch_scc1 LA_offered
  s_or_b32 s49, s68, 1
  v_mov_b32 v118, s49
  s_mov_b64 exec, 1
  global_atomic_cmpswap v119, v[118:119], s[52:53] sc1
  s_mov_b64 exec, -1
LA_offered:
  s_add_u32 s32, s54, 0xfffff
  s_addc_u32 s33, s55, 0
  s_and_b32 s32, s32, 0xfff00000
  s_lshl2_add_u32 s50, s41, s40
  s_lshl_b32 s50, s50, 17
  s_add_u32 s28, s32, s50
  s_addc_u32 s29, s33, 0
  s_add_u32 s32, s32, s59
  s_addc_u32 s33, s33, 0
  s_cmp_lg_u32 s40, 3
  s_cbranch_scc1 LA_notouch
  s_load_dword s45, s[32:33], 11264
  s_load_dword s45, s[32:33], 11328
LA_notouch:
  v_lshlrev_b32 v121, 3, v159
  v_cvt_f32_u32 v121, v121
  s_mov_b32 s50, 0xbe549a78
  v_mul_f32 v200, s50, v121
  v_add_f32 v121, 1.0, v121
  v_mul_f32 v201, s50, v121
  v_add_f32 v121, 1.0, v121
  v_mul_f32 v202, s50, v121
  v_add_f32 v121, 1.0, v121
  v_mul_f32 v203, s50, v121
  v_add_f32 v121, 1.0, v121
  v_mul_f32 v204, s50, v121
  v_add_f32 v121, 1.0, v121
  v_mul_f32 v205, s50, v121
  v_add_f32 v121, 1.0, v121
  v_mul_f32 v206, s50, v121
  v_add_f32 v121, 1.0, v121
  v_mul_f32 v207, s50, v121
  v_exp_f32 v200, v200
  v_exp_f32 v201, v201
  v_exp_f32 v202, v202
  v_exp_f32 v203, v203
  v_exp_f32 v204, v204
  v_exp_f32 v205, v205
  v_exp_f32 v206, v206
  v_exp_f32 v207, v207
  s_and_b32 s50, s48, 63
  s_lshl_b32 s50, s50, 5
  v_add_u32 v208, s50, v158
  v_mov_b32 v211, 0.15915494
  v_mov_b32 v212, 0x3e0293ee
  v_cvt_f32_u32 v210, v208
  v_pk_mul_f32 v[32:33], v[200:201], v[210:211] op_sel_hi:[1,0]
  v_pk_mul_f32 v[34:35], v[202:203], v[210:211] op_sel_hi:[1,0]
  v_pk_mul_f32 v[36:37], v[204:205], v[210:211] op_sel_hi:[1,0]
  v_pk_mul_f32 v[38:39], v[206:207], v[210:211] op_sel_hi:[1,0]
  v_pk_mul_f32 v[32:33], v[32:33], v[210:211] op_sel:[0,1] op_sel_hi:[1,1]
  v_pk_mul_f32 v[34:35], v[34:35], v[210:211] op_sel:[0,1] op_sel_hi:[1,1]
  v_pk_mul_f32 v[36:37], v[36:37], v[210:211] op_sel:[0,1] op_sel_hi:[1,1]
  v_pk_mul_f32 v[38:39], v[38:39], v[210:211] op_sel:[0,1] op_sel_hi:[1,1]
  v_fract_f32 v32, v32
  v_fract_f32 v33, v33
  v_fract_f32 v34, v34
  v_fract_f32 v35, v35
  v_fract_f32 v36, v36
  v_fract_f32 v37, v37
  v_fract_f32 v38, v38
  v_fract_f32 v39, v39
  v_sin_f32 v40, v32
  v_sin_f32 v41, v33
  v_sin_f32 v42, v34
  v_sin_f32 v43, v35
  v_sin_f32 v44, v36
  v_sin_f32 v45, v37
  v_sin_f32 v46, v38
  v_sin_f32 v47, v39
  v_cos_f32 v32, v32
  v_cos_f32 v33, v33
  v_cos_f32 v34, v34
  v_cos_f32 v35, v35
  v_cos_f32 v36, v36
  v_cos_f32 v37, v37
  v_cos_f32 v38, v38
  v_cos_f32 v39, v39
  v_xor_b32 v208, 0x400, v208
  v_cvt_pk_bf16_f32 v120, v32, v40
  v_cvt_pk_bf16_f32 v121, v33, v41
  v_cvt_pk_bf16_f32 v122, v34, v42
  v_cvt_pk_bf16_f32 v123, v35, v43
  v_cvt_pk_bf16_f32 v124, v36, v44
  v_cvt_pk_bf16_f32 v125, v37, v45
  v_cvt_pk_bf16_f32 v126, v38, v46
  v_cvt_pk_bf16_f32 v127, v39, v47
  v_lshlrev_b32 v32, 16, v120
  v_and_b32 v40, 0xffff0000, v120
  v_lshlrev_b32 v33, 16, v121
  v_and_b32 v41, 0xffff0000, v121
  v_lshlrev_b32 v34, 16, v122
  v_and_b32 v42, 0xffff0000, v122
  v_lshlrev_b32 v35, 16, v123
  v_and_b32 v43, 0xffff0000, v123
  v_lshlrev_b32 v36, 16, v124
  v_and_b32 v44, 0xffff0000, v124
  v_lshlrev_b32 v37, 16, v125
  v_and_b32 v45, 0xffff0000, v125
  v_lshlrev_b32 v38, 16, v126
  v_and_b32 v46, 0xffff0000, v126
  v_lshlrev_b32 v39, 16, v127
  v_and_b32 v47, 0xffff0000, v127
  v_pk_mul_f32 v[48:49], v[32:33], v[212:213] op_sel_hi:[1,0]
  v_pk_mul_f32 v[50:51], v[34:35], v[212:213] op_sel_hi:[1,0]
  v_pk_mul_f32 v[52:53], v[36:37], v[212:213] op_sel_hi:[1,0]
  v_pk_mul_f32 v[54:55], v[38:39], v[212:213] op_sel_hi:[1,0]
  v_pk_mul_f32 v[56:57], v[40:41], v[212:213] op_sel_hi:[1,0]
  v_pk_mul_f32 v[58:59], v[42:43], v[212:213] op_sel_hi:[1,0]
  v_pk_mul_f32 v[60:61], v[44:45], v[212:213] op_sel_hi:[1,0]
  v_pk_mul_f32 v[62:63], v[46:47], v[212:213] op_sel_hi:[1,0]
  s_mul_i32 s50, s40, 2304
  s_movk_i32 s51, 144
  v_lshrrev_b32 v163, 3, v174
  v_lshl_add_u32 v162, v159, 4, s50
  v_mad_u32_u24 v162, v163, s51, v162
  v_lshlrev_b32 v164, 8, v163
  v_lshl_add_u32 v164, v159, 4, v164
  v_lshl_add_u32 v163, v163, 4, s50
  v_mad_u32_u24 v163, v159, s51, v163
  s_lshr_b32 s50, s40, 1
  s_lshl_b32 s50, s50, 5
  s_and_b32 s51, s40, 1
  s_add_u32 s50, s50, s51
  s_lshl_b32 s50, s50, 7
  v_add_u32 v164, s50, v164
  v_and_b32 v170, 15, v174
  v_lshl_add_u32 v0, v170, 3, s50
  v_lshl_add_u32 v0, v160, 10, v0
  s_lshl_b32 s50, s40, 8
  s_add_u32 s50, s50, 0x2000
  v_lshl_add_u32 v165, v170, 4, s50
  v_lshl_add_u32 v165, v160, 10, v165
  s_mov_b32 s56, 0x2b800000
  s_mov_b32 s57, 0x53800000
  s_movk_i32 s58, 0x207
  v_mov_b32 v175, 0x7fc00000
  s_lshr_b32 s50, s40, 1
  s_lshl_b32 s50, s50, 8
  s_add_u32 s50, s50, 98304
  v_and_b32 v170, 3, v174
  v_lshl_add_u32 v7, v170, 4, s50
  v_lshl_add_u32 v7, v160, 6, v7
  s_lshl_b32 s50, s40, 9
  v_and_b32_e64 v170, 12, v174
  v_add3_u32 v13, v7, v170, s50
  v_accvgpr_write_b32 a64, -1
  v_accvgpr_write_b32 a65, -1
  v_accvgpr_write_b32 a66, -1
  v_accvgpr_write_b32 a67, -1
  v_add_u32 v2, 0x1000, v1
  v_add_u32 v239, 0x2000, v1
  s_and_b32 s50, s40, 1
  s_lshl_b32 s50, s50, 10
  v_add_u32_e64 v3, s50, v239
  v_xor_b32 v232, 0x400, v3
  v_mul_u32_u24 v166, 528, v159
  v_lshl_add_u32 v166, v158, 4, v166
  v_add_u32 v166, 115200, v166
  v_mul_u32_u24 v167, 272, v160
  s_lshr_b32 s50, s40, 1
  s_lshl_b32 s50, s50, 8
  s_xor_b32 s51, s50, 256
  s_add_u32 s50, s50, 115200
  s_add_u32 s51, s51, 115200
  v_add3_u32 v168, v167, v1, s51
  v_add3_u32 v167, v167, v1, s50
  s_mul_i32 s50, s40, 2560
  v_lshl_add_u32 v169, v174, 7, s50
  v_and_b32 v161, 7, v174
  s_lshr_b32 s50, s2, 6
  s_cmp_eq_u32 s50, s40
  s_cselect_b32 s50, 6, 7
  v_min_u32 v161, s50, v161
  v_xor_b32 v161, s46, v161
  v_lshlrev_b32 v161, 14, v161
  v_add_u32 v161, 11264, v161
  s_mul_i32 s50, s40, 24576
  v_add_u32 v6, s50, v1
  s_xor_b32 s50, s40, 1
  s_mul_i32 s50, s50, 24576
  v_add_u32 v233, s50, v1
  s_xor_b32 s50, s40, 2
  s_mul_i32 s50, s50, 24576
  v_add_u32 v234, s50, v1
  s_xor_b32 s50, s40, 3
  s_mul_i32 s50, s50, 24576
  v_add_u32 v235, s50, v1
  v_lshlrev_b32 v15, 1, v174
  v_lshl_add_u32 v15, v159, 12, v15
  v_lshlrev_b32 v12, 5, v160
  s_lshl_b32 s3, s48, 13
  s_lshl_b32 s43, s46, 14
  s_or_b32 s43, s43, s28
  s_mov_b32 s60, s43
  s_xor_b32 s64, s43, 0x4000
  s_mov_b32 s61, s29
  s_mov_b32 s62, 0x4000
  s_mov_b32 s63, 0x20000
  s_mov_b32 s65, s29
  s_mov_b32 s66, 0x4000
  s_mov_b32 s67, 0x20000
  s_lshl_b32 s50, s40, 12
  s_add_u32 s50, s50, 0x400000
  s_add_u32 s72, s32, s50
  s_addc_u32 s73, s33, 0
  s_xor_b32 s76, s72, 0x80000
  s_mov_b32 s77, s73
  s_mov_b32 s74, 2304
  s_mov_b32 s75, 0x20000
  s_mov_b32 s78, 2304
  s_mov_b32 s79, 0x20000
  s_mov_b32 s36, s26
  s_mov_b32 s37, s27
  s_mov_b32 s38, 2097152
  s_mov_b32 s39, 0x20000
  s_add_u32 s80, s32, 11264
  s_addc_u32 s81, s33, 0
  s_cmp_eq_u32 s40, 0
  s_cselect_b32 s82, 128, 0
  s_mov_b32 s83, 0x20000
  s_waitcnt vmcnt(12)
  v_lshlrev_b32 v136, 16, v112
  v_and_b32 v137, 0xffff0000, v112
  v_lshlrev_b32 v138, 16, v113
  v_and_b32 v139, 0xffff0000, v113
  v_max3_f32 v170, v136, v137, v138
  v_min3_f32 v171, v136, v137, v138
  v_max_f32 v170, v170, v139
  v_min_f32 v171, v171, v139
  v_rcp_f32 v140, v136
  v_rcp_f32 v141, v137
  v_rcp_f32 v142, v138
  v_rcp_f32 v143, v139
  v_cmp_gt_f32 vcc, s56, v171
  v_cmp_lt_f32 s[50:51], s57, v170
  v_log_f32 v136, v136
  v_log_f32 v137, v137
  v_log_f32 v138, v138
  v_log_f32 v139, v139
  s_or_b64 vcc, vcc, s[50:51]
  s_lshl_b32 s50, s46, 7
  v_xor_b32 v170, s50, v1
  v_cndmask_b32 v136, v136, v175, vcc
  s_lshl_b32 s50, s40, 10
  s_add_u32 s50, s50, 111104
  v_add_u32 v171, s50, v170
  ds_write_b128 v171, v[136:139]
  v_lshl_add_u32 v4, v160, 4, s50
  ds_read_b128 v[192:195], v4 offset:0
  ds_read_b128 v[196:199], v4 offset:64
  v_cvt_pk_bf16_f32 v112, v140, v141
  v_cvt_pk_bf16_f32 v113, v142, v143
  v_lshlrev_b32 v144, 16, v112
  v_and_b32 v145, 0xffff0000, v112
  v_lshlrev_b32 v146, 16, v113
  v_and_b32 v147, 0xffff0000, v113
  v_pk_add_f32 v[140:141], v[140:141], v[144:145] neg_lo:[0,1] neg_hi:[0,1]
  v_pk_add_f32 v[142:143], v[142:143], v[146:147] neg_lo:[0,1] neg_hi:[0,1]
  v_cvt_pk_bf16_f32 v140, v140, v141
  v_cvt_pk_bf16_f32 v141, v142, v143
  v_mov_b32 v144, 0
  v_mov_b32 v145, 0
  s_mul_i32 s50, s40, 2176
  s_add_u32 s50, s50, 102400
  v_lshrrev_b32 v170, 7, v170
  v_mul_u32_u24 v170, 272, v170
  v_and_b32 v171, 3, v174
  v_lshl_add_u32 v170, v171, 6, v170
  v_lshl_add_u32 v5, v171, 4, s50
  v_lshl_add_u32 v5, v160, 6, v5
  v_and_b32 v171, 4, v174
  v_lshl_add_u32 v170, v171, 1, v170
  v_add_u32 v170, s50, v170
  ds_write2_b64 v170, v[112:113], v[140:141] offset0:0 offset1:2
  ds_write2_b64 v170, v[114:115], v[144:145] offset0:4 offset1:6
  s_waitcnt vmcnt(6)
  v_cvt_f32_i32 v16, v16
  v_cvt_f32_i32 v17, v17
  v_cvt_f32_i32 v18, v18
  v_cvt_f32_i32 v19, v19
  v_cvt_f32_i32 v20, v20
  v_cvt_f32_i32 v21, v21
  v_cvt_f32_i32 v22, v22
  v_cvt_f32_i32 v23, v23
  v_cvt_f32_i32 v24, v24
  v_cvt_f32_i32 v25, v25
  v_cvt_f32_i32 v26, v26
  v_cvt_f32_i32 v27, v27
  v_cvt_f32_i32 v28, v28
  v_cvt_f32_i32 v29, v29
  v_cvt_f32_i32 v30, v30
  v_cvt_f32_i32 v31, v31
  v_mul_f32 v117, v117, v116
  v_pk_fma_f32 v[16:17], v[16:17], v[116:117], v[116:117] op_sel:[0,0,1] op_sel_hi:[1,0,1] neg_lo:[0,0,1] neg_hi:[0,0,1]
  v_pk_fma_f32 v[18:19], v[18:19], v[116:117], v[116:117] op_sel:[0,0,1] op_sel_hi:[1,0,1] neg_lo:[0,0,1] neg_hi:[0,0,1]
  v_pk_fma_f32 v[20:21], v[20:21], v[116:117], v[116:117] op_sel:[0,0,1] op_sel_hi:[1,0,1] neg_lo:[0,0,1] neg_hi:[0,0,1]
  v_pk_fma_f32 v[22:23], v[22:23], v[116:117], v[116:117] op_sel:[0,0,1] op_sel_hi:[1,0,1] neg_lo:[0,0,1] neg_hi:[0,0,1]
  v_pk_fma_f32 v[24:25], v[24:25], v[116:117], v[116:117] op_sel:[0,0,1] op_sel_hi:[1,0,1] neg_lo:[0,0,1] neg_hi:[0,0,1]
  v_pk_fma_f32 v[26:27], v[26:27], v[116:117], v[116:117] op_sel:[0,0,1] op_sel_hi:[1,0,1] neg_lo:[0,0,1] neg_hi:[0,0,1]
  v_pk_fma_f32 v[28:29], v[28:29], v[116:117], v[116:117] op_sel:[0,0,1] op_sel_hi:[1,0,1] neg_lo:[0,0,1] neg_hi:[0,0,1]
  v_pk_fma_f32 v[30:31], v[30:31], v[116:117], v[116:117] op_sel:[0,0,1] op_sel_hi:[1,0,1] neg_lo:[0,0,1] neg_hi:[0,0,1]
  v_pk_mul_f32 v[120:121], v[16:17], v[32:33]
  v_pk_mul_f32 v[122:123], v[24:25], v[32:33]
  v_pk_fma_f32 v[120:121], v[24:25], v[40:41], v[120:121] neg_lo:[1,0,0] neg_hi:[1,0,0]
  v_pk_fma_f32 v[122:123], v[16:17], v[40:41], v[122:123]
  v_cvt_pk_bf16_f32 v128, v120, v121
  v_cvt_pk_bf16_f32 v132, v122, v123
  v_pk_mul_f32 v[124:125], v[18:19], v[34:35]
  v_pk_mul_f32 v[126:127], v[26:27], v[34:35]
  v_pk_fma_f32 v[124:125], v[26:27], v[42:43], v[124:125] neg_lo:[1,0,0] neg_hi:[1,0,0]
  v_pk_fma_f32 v[126:127], v[18:19], v[42:43], v[126:127]
  v_cvt_pk_bf16_f32 v129, v124, v125
  v_cvt_pk_bf16_f32 v133, v126, v127
  v_pk_mul_f32 v[120:121], v[20:21], v[36:37]
  v_pk_mul_f32 v[122:123], v[28:29], v[36:37]
  v_pk_fma_f32 v[120:121], v[28:29], v[44:45], v[120:121] neg_lo:[1,0,0] neg_hi:[1,0,0]
  v_pk_fma_f32 v[122:123], v[20:21], v[44:45], v[122:123]
  v_cvt_pk_bf16_f32 v130, v120, v121
  v_cvt_pk_bf16_f32 v134, v122, v123
  v_pk_mul_f32 v[124:125], v[22:23], v[38:39]
  v_pk_mul_f32 v[126:127], v[30:31], v[38:39]
  v_pk_fma_f32 v[124:125], v[30:31], v[46:47], v[124:125] neg_lo:[1,0,0] neg_hi:[1,0,0]
  v_pk_fma_f32 v[126:127], v[22:23], v[46:47], v[126:127]
  v_cvt_pk_bf16_f32 v131, v124, v125
  v_cvt_pk_bf16_f32 v135, v126, v127
  ds_write_b128 v162, v[128:131]
  ds_write_b128 v162, v[132:135] offset:1152
  ds_read_b128 v[24:27], v163
  ds_read_b128 v[28:31], v163 offset:1152
  s_waitcnt lgkmcnt(0)
  global_store_dwordx4 v164, v[24:27], s[32:33] sc1
  global_store_dwordx4 v164, v[28:31], s[32:33] offset:2048 sc1
  v_cvt_f32_u32 v210, v208
  v_pk_mul_f32 v[64:65], v[200:201], v[210:211] op_sel_hi:[1,0]
  v_pk_mul_f32 v[66:67], v[202:203], v[210:211] op_sel_hi:[1,0]
  v_pk_mul_f32 v[68:69], v[204:205], v[210:211] op_sel_hi:[1,0]
  v_pk_mul_f32 v[70:71], v[206:207], v[210:211] op_sel_hi:[1,0]
  v_pk_mul_f32 v[64:65], v[64:65], v[210:211] op_sel:[0,1] op_sel_hi:[1,1]
  v_pk_mul_f32 v[66:67], v[66:67], v[210:211] op_sel:[0,1] op_sel_hi:[1,1]
  v_pk_mul_f32 v[68:69], v[68:69], v[210:211] op_sel:[0,1] op_sel_hi:[1,1]
  v_pk_mul_f32 v[70:71], v[70:71], v[210:211] op_sel:[0,1] op_sel_hi:[1,1]
  v_fract_f32 v64, v64
  v_fract_f32 v65, v65
  v_fract_f32 v66, v66
  v_fract_f32 v67, v67
  v_fract_f32 v68, v68
  v_fract_f32 v69, v69
  v_fract_f32 v70, v70
  v_fract_f32 v71, v71
  v_sin_f32 v72, v64
  v_sin_f32 v73, v65
  v_sin_f32 v74, v66
  v_sin_f32 v75, v67
  v_sin_f32 v76, v68
  v_sin_f32 v77, v69
  v_sin_f32 v78, v70
  v_sin_f32 v79, v71
  v_cos_f32 v64, v64
  v_cos_f32 v65, v65
  v_cos_f32 v66, v66
  v_cos_f32 v67, v67
  v_cos_f32 v68, v68
  v_cos_f32 v69, v69
  v_cos_f32 v70, v70
  v_cos_f32 v71, v71
  v_xor_b32 v208, 0x400, v208
  v_cvt_pk_bf16_f32 v120, v64, v72
  v_cvt_pk_bf16_f32 v121, v65, v73
  v_cvt_pk_bf16_f32 v122, v66, v74
  v_cvt_pk_bf16_f32 v123, v67, v75
  v_cvt_pk_bf16_f32 v124, v68, v76
  v_cvt_pk_bf16_f32 v125, v69, v77
  v_cvt_pk_bf16_f32 v126, v70, v78
  v_cvt_pk_bf16_f32 v127, v71, v79
  v_lshlrev_b32 v64, 16, v120
  v_and_b32 v72, 0xffff0000, v120
  v_lshlrev_b32 v65, 16, v121
  v_and_b32 v73, 0xffff0000, v121
  v_lshlrev_b32 v66, 16, v122
  v_and_b32 v74, 0xffff0000, v122
  v_lshlrev_b32 v67, 16, v123
  v_and_b32 v75, 0xffff0000, v123
  v_lshlrev_b32 v68, 16, v124
  v_and_b32 v76, 0xffff0000, v124
  v_lshlrev_b32 v69, 16, v125
  v_and_b32 v77, 0xffff0000, v125
  v_lshlrev_b32 v70, 16, v126
  v_and_b32 v78, 0xffff0000, v126
  v_lshlrev_b32 v71, 16, v127
  v_and_b32 v79, 0xffff0000, v127
  v_pk_mul_f32 v[64:65], v[64:65], v[212:213] op_sel_hi:[1,0]
  v_pk_mul_f32 v[66:67], v[66:67], v[212:213] op_sel_hi:[1,0]
  v_pk_mul_f32 v[68:69], v[68:69], v[212:213] op_sel_hi:[1,0]
  v_pk_mul_f32 v[70:71], v[70:71], v[212:213] op_sel_hi:[1,0]
  v_pk_mul_f32 v[72:73], v[72:73], v[212:213] op_sel_hi:[1,0]
  v_pk_mul_f32 v[74:75], v[74:75], v[212:213] op_sel_hi:[1,0]
  v_pk_mul_f32 v[76:77], v[76:77], v[212:213] op_sel_hi:[1,0]
  v_pk_mul_f32 v[78:79], v[78:79], v[212:213] op_sel_hi:[1,0]
  s_waitcnt vmcnt(4)
  s_nop 0
  v_or3_b32 v120, v80, v81, v82
  v_or3_b32 v121, v92, v93, v94
  v_or3_b32 v120, v120, v83, v95
  v_lshl_or_b32 v80, v84, 4, v80
  v_lshl_or_b32 v81, v85, 4, v81
  v_lshl_or_b32 v82, v86, 4, v82
  v_lshl_or_b32 v83, v87, 4, v83
  v_lshl_or_b32 v92, v92, 4, v88
  v_lshl_or_b32 v93, v93, 4, v89
  v_lshl_or_b32 v94, v94, 4, v90
  v_lshl_or_b32 v95, v95, 4, v91
  v_lshl_or_b32 v92, v92, 8, v80
  v_lshl_or_b32 v93, v93, 8, v81
  v_lshl_or_b32 v94, v94, 8, v82
  v_lshl_or_b32 v95, v95, 8, v83
  v_or3_b32 v121, v121, v84, v85
  v_or3_b32 v120, v120, v86, v87
  v_permlane32_swap_b32 v92, v80
  v_permlane32_swap_b32 v93, v81
  v_permlane32_swap_b32 v94, v82
  v_permlane32_swap_b32 v95, v83
  v_lshl_or_b32 v92, v80, 16, v92
  v_lshl_or_b32 v93, v81, 16, v93
  v_lshl_or_b32 v94, v82, 16, v94
  v_lshl_or_b32 v95, v83, 16, v95
  s_mov_b32 exec_hi, 0
  global_store_dwordx4 v165, v[92:95], s[32:33] sc1
  s_mov_b32 exec_hi, -1
  v_or3_b32 v121, v121, v88, v89
  v_or3_b32 v120, v120, v90, v91
  v_or_b32 v120, v120, v121
  v_cmp_lt_u32 s[70:71], 3, v120
  s_mov_b64 exec, 1
  global_load_dword v118, v119, s[52:53] offset:0 sc1
  s_mov_b64 exec, -1
  s_barrier
  global_load_dwordx4 v[104:107], v156, s[4:5] offset:0
  global_load_dwordx4 v[108:111], v156, s[4:5] offset:128
  s_waitcnt vmcnt(6)
  v_lshlrev_b32 v136, 16, v96
  v_and_b32 v137, 0xffff0000, v96
  v_lshlrev_b32 v138, 16, v97
  v_and_b32 v139, 0xffff0000, v97
  v_lshlrev_b32 v140, 16, v98
  v_and_b32 v141, 0xffff0000, v98
  v_lshlrev_b32 v142, 16, v99
  v_and_b32 v143, 0xffff0000, v99
  v_lshlrev_b32 v144, 16, v100
  v_and_b32 v145, 0xffff0000, v100
  v_lshlrev_b32 v146, 16, v101
  v_and_b32 v147, 0xffff0000, v101
  v_lshlrev_b32 v148, 16, v102
  v_and_b32 v149, 0xffff0000, v102
  v_lshlrev_b32_e64 v150, 16, v103
  v_and_b32 v151, 0xffff0000, v103
  v_pk_mul_f32 v[120:121], v[136:137], v[48:49]
  v_pk_mul_f32 v[122:123], v[144:145], v[48:49]
  v_pk_fma_f32 v[120:121], v[144:145], v[56:57], v[120:121] neg_lo:[1,0,0] neg_hi:[1,0,0]
  v_pk_fma_f32 v[122:123], v[136:137], v[56:57], v[122:123]
  v_cvt_pk_bf16_f32 v96, v120, v121
  v_cvt_pk_bf16_f32 v100, v122, v123
  v_pk_mul_f32 v[124:125], v[138:139], v[50:51]
  v_pk_mul_f32 v[126:127], v[146:147], v[50:51]
  v_pk_fma_f32 v[124:125], v[146:147], v[58:59], v[124:125] neg_lo:[1,0,0] neg_hi:[1,0,0]
  v_pk_fma_f32 v[126:127], v[138:139], v[58:59], v[126:127]
  v_cvt_pk_bf16_f32 v97, v124, v125
  v_cvt_pk_bf16_f32 v101, v126, v127
  v_pk_mul_f32 v[120:121], v[140:141], v[52:53]
  v_pk_mul_f32 v[122:123], v[148:149], v[52:53]
  v_pk_fma_f32 v[120:121], v[148:149], v[60:61], v[120:121] neg_lo:[1,0,0] neg_hi:[1,0,0]
  v_pk_fma_f32 v[122:123], v[140:141], v[60:61], v[122:123]
  v_cvt_pk_bf16_f32 v98, v120, v121
  v_cvt_pk_bf16_f32 v102, v122, v123
  v_pk_mul_f32 v[124:125], v[142:143], v[54:55]
  v_pk_mul_f32 v[126:127], v[150:151], v[54:55]
  v_pk_fma_f32 v[124:125], v[150:151], v[62:63], v[124:125] neg_lo:[1,0,0] neg_hi:[1,0,0]
  v_pk_fma_f32 v[126:127], v[142:143], v[62:63], v[126:127]
  v_cvt_pk_bf16_f32 v99, v124, v125
  v_cvt_pk_bf16_f32 v103, v126, v127
  ds_write_b128 v166, v[96:99] offset:8448
  ds_write_b128 v166, v[100:103] offset:12672
  s_cmp_lg_u64 s[70:71], 0
  s_cbranch_scc1 LA_poison
LA_clean:
  s_mov_b32 s44, 0
  s_waitcnt vmcnt(2) lgkmcnt(0)
  v_readfirstlane_b32 s49, v118
  s_cmp_eq_u32 s49, 0
  s_cbranch_scc1 LA_mktag
LA_tagged:
  s_cmp_lg_u32 s40, 0
  s_mov_b64 exec, 1
  s_barrier
  s_cbranch_scc1 LA_noflag
  global_store_dword v239, v118, s[32:33] offset:3072
LA_noflag:
  s_mov_b64 exec, 0xff
  global_load_dword v14, v161, s[28:29] offset:0 sc1
  s_mov_b64 exec, -1
  ds_read_b128 a[160:163], v167 offset:8448
  ds_read_b128 a[176:179], v168 offset:8448
  ds_read_b128 a[164:167], v167 offset:10560
  ds_read_b128 a[180:183], v168 offset:10560
  ds_read_b128 a[168:171], v167 offset:12672
  ds_read_b128 a[184:187], v168 offset:12672
  ds_read_b128 a[172:175], v167 offset:14784
  ds_read_b128 a[188:191], v168 offset:14784
  s_mov_b64 exec, 0xfffff
  global_load_dword a8, v169, s[32:33] sc1
  s_mov_b64 exec, -1
  v_accvgpr_write_b32 a68, v118
  s_waitcnt vmcnt(1)
  s_mov_b64 exec, 0xff
  s_cbranch_scc1 LA_look1
  global_store_dwordx4 v239, v[118:121], s[32:33] offset:3200 sc1
LA_look1:
  v_cmp_ne_u32 vcc, s49, v14
  s_and_b32 s50, vcc_lo, 255
  s_cbranch_scc0 LA_fast
  s_mov_b64 exec, -1
  v_lshlrev_b32 v136, 16, v104
  v_and_b32 v137, 0xffff0000, v104
  v_lshlrev_b32 v138, 16, v105
  v_and_b32 v139, 0xffff0000, v105
  v_lshlrev_b32 v140, 16, v106
  v_and_b32 v141, 0xffff0000, v106
  v_lshlrev_b32 v142, 16, v107
  v_and_b32 v143, 0xffff0000, v107
  v_lshlrev_b32 v144, 16, v108
  v_and_b32 v145, 0xffff0000, v108
  v_lshlrev_b32 v146, 16, v109
  v_and_b32 v147, 0xffff0000, v109
  v_lshlrev_b32 v148, 16, v110
  v_and_b32 v149, 0xffff0000, v110
  v_lshlrev_b32 v150, 16, v111
  v_and_b32 v151, 0xffff0000, v111
  v_pk_mul_f32 v[120:121], v[136:137], v[64:65]
  v_pk_mul_f32 v[122:123], v[144:145], v[64:65]
  v_pk_fma_f32 v[120:121], v[144:145], v[72:73], v[120:121] neg_lo:[1,0,0] neg_hi:[1,0,0]
  v_pk_fma_f32 v[122:123], v[136:137], v[72:73], v[122:123]
  v_cvt_pk_bf16_f32 v104, v120, v121
  v_cvt_pk_bf16_f32 v108, v122, v123
  v_pk_mul_f32 v[124:125], v[138:139], v[66:67]
  v_pk_mul_f32 v[126:127], v[146:147], v[66:67]
  v_pk_fma_f32 v[124:125], v[146:147], v[74:75], v[124:125] neg_lo:[1,0,0] neg_hi:[1,0,0]
  v_pk_fma_f32 v[126:127], v[138:139], v[74:75], v[126:127]
  v_cvt_pk_bf16_f32 v105, v124, v125
  v_cvt_pk_bf16_f32 v109, v126, v127
  v_pk_mul_f32 v[120:121], v[140:141], v[68:69]
  v_pk_mul_f32 v[122:123], v[148:149], v[68:69]
  v_pk_fma_f32 v[120:121], v[148:149], v[76:77], v[120:121] neg_lo:[1,0,0] neg_hi:[1,0,0]
  v_pk_fma_f32 v[122:123], v[140:141], v[76:77], v[122:123]
  v_cvt_pk_bf16_f32 v106, v120, v121
  v_cvt_pk_bf16_f32 v110, v122, v123
  v_pk_mul_f32 v[124:125], v[142:143], v[70:71]
  v_pk_mul_f32 v[126:127], v[150:151], v[70:71]
  v_pk_fma_f32 v[124:125], v[150:151], v[78:79], v[124:125] neg_lo:[1,0,0] neg_hi:[1,0,0]
  v_pk_fma_f32 v[126:127], v[142:143], v[78:79], v[126:127]
  v_cvt_pk_bf16_f32 v107, v124, v125
  v_cvt_pk_bf16_f32 v111, v126, v127
  ds_write_b128 v166, v[104:107] offset:0
  ds_write_b128 v166, v[108:111] offset:4224
  global_load_dword v14, v161, s[28:29] offset:0 sc1
  s_waitcnt lgkmcnt(0)
  s_barrier
  ds_read_b128 a[128:131], v167 offset:0
  ds_read_b128 a[144:147], v168 offset:0
  ds_read_b128 a[132:135], v167 offset:2112
  ds_read_b128 a[148:151], v168 offset:2112
  ds_read_b128 a[136:139], v167 offset:4224
  ds_read_b128 a[152:155], v168 offset:4224
  ds_read_b128 a[140:143], v167 offset:6336
  ds_read_b128 a[156:159], v168 offset:6336
  s_waitcnt vmcnt(0)
  v_cmp_ne_u32 vcc, s49, v14
  s_and_b32 s50, vcc_lo, 255
  s_cbranch_scc1 LA_blk0
LA_ret0:
  s_nop 0
  buffer_load_dwordx4 a[192:195], v1, s[60:63], 0 offen offset:0 sc1
  buffer_load_dwordx4 a[196:199], v1, s[60:63], 0 offen offset:1024 sc1
  buffer_load_dwordx4 a[200:203], v1, s[60:63], 0 offen offset:2048 sc1
  buffer_load_dwordx4 a[204:207], v1, s[60:63], 0 offen offset:3072 sc1
  buffer_load_dwordx4 a[208:211], v2, s[60:63], 0 offen offset:0 sc1
  buffer_load_dwordx4 a[212:215], v2, s[60:63], 0 offen offset:1024 sc1
  buffer_load_dwordx4 a[216:219], v2, s[60:63], 0 offen offset:2048 sc1
  buffer_load_dwordx4 a[220:223], v2, s[60:63], 0 offen offset:3072 sc1
LA_go:
  s_waitcnt lgkmcnt(0)
LA_main:
  v_xor_b32 v13, 0x100, v13
  s_waitcnt vmcnt(7)
  v_mfma_f32_16x16x32_bf16 v[16:19], a[192:195], a[128:131], v[192:195]
  buffer_load_dwordx4 v[176:179], v3, s[60:63], 0 offen sc1
  ds_read_b128 a[0:3], v5 offset:0
  v_mfma_f32_16x16x32_bf16 v[24:27], a[192:195], a[144:147], v[192:195]
  ds_read_b128 v[200:203], v4 offset:128
  ds_read_b128 v[204:207], v4 offset:192
  v_mfma_f32_16x16x32_bf16 v[32:35], a[192:195], a[160:163], v[192:195]
  ds_read_b128 a[4:7], v5 offset:272
  v_mfma_f32_16x16x32_bf16 v[40:43], a[192:195], a[176:179], v[192:195]
  ds_read_b128 v[192:195], v4 offset:256
  s_waitcnt vmcnt(7)
  v_mfma_f32_16x16x32_bf16 v[16:19], a[196:199], a[132:135], v[16:19]
  buffer_load_dwordx4 v[180:183], v232, s[60:63], 0 offen sc1
  v_mfma_f32_16x16x32_bf16 v[24:27], a[196:199], a[148:151], v[24:27]
  s_xor_b32 s60, s43, 0x8000
  v_mfma_f32_16x16x32_bf16 v[32:35], a[196:199], a[164:167], v[32:35]
  v_mfma_f32_16x16x32_bf16 v[40:43], a[196:199], a[180:183], v[40:43]
  s_waitcnt vmcnt(7)
  v_mfma_f32_16x16x32_bf16 v[16:19], a[200:203], a[136:139], v[16:19]
  buffer_load_dwordx4 a[224:227], v1, s[64:67], 0 offen offset:0 sc1
  v_mfma_f32_16x16x32_bf16 v[24:27], a[200:203], a[152:155], v[24:27]
  v_mfma_f32_16x16x32_bf16 v[32:35], a[200:203], a[168:171], v[32:35]
  v_mfma_f32_16x16x32_bf16 v[40:43], a[200:203], a[184:187], v[40:43]
  s_waitcnt vmcnt(7)
  v_mfma_f32_16x16x32_bf16 v[16:19], a[204:207], a[140:143], v[16:19]
  buffer_load_dwordx4 a[228:231], v1, s[64:67], 0 offen offset:1024 sc1
  s_nop 0
  v_mfma_f32_16x16x32_bf16 v[24:27], a[204:207], a[156:159], v[24:27]
  s_nop 1
  v_mfma_f32_16x16x32_bf16 v[32:35], a[204:207], a[172:175], v[32:35]
  s_nop 1
  v_mfma_f32_16x16x32_bf16 v[40:43], a[204:207], a[188:191], v[40:43]
  v_exp_f32 v16, v16
  s_waitcnt vmcnt(7)
  v_mfma_f32_16x16x32_bf16 v[20:23], a[208:211], a[128:131], v[196:199]
  buffer_load_dwordx4 a[232:235], v1, s[64:67], 0 offen offset:2048 sc1
  s_nop 0
  v_mfma_f32_16x16x32_bf16 v[28:31], a[208:211], a[144:147], v[196:199]
  v_exp_f32 v17, v17
  v_mfma_f32_16x16x32_bf16 v[36:39], a[208:211], a[160:163], v[196:199]
  v_exp_f32 v18, v18
  v_mfma_f32_16x16x32_bf16 v[44:47], a[208:211], a[176:179], v[196:199]
  ds_read_b128 v[196:199], v4 offset:320
  v_cvt_pk_bf16_f32 v80, v16, v17
  s_waitcnt vmcnt(7)
  v_mfma_f32_16x16x32_bf16 v[20:23], a[212:215], a[132:135], v[20:23]
  buffer_load_dwordx4 a[236:239], v1, s[64:67], 0 offen offset:3072 sc1
  v_mfma_f32_16x16x32_bf16 v[28:31], a[212:215], a[148:151], v[28:31]
  v_exp_f32 v19, v19
  v_mfma_f32_16x16x32_bf16 v[36:39], a[212:215], a[164:167], v[36:39]
  v_exp_f32 v24, v24
  v_mfma_f32_16x16x32_bf16 v[44:47], a[212:215], a[180:183], v[44:47]
  v_exp_f32 v25, v25
  s_waitcnt vmcnt(7)
  v_mfma_f32_16x16x32_bf16 v[20:23], a[216:219], a[136:139], v[20:23]
  buffer_load_dwordx4 v[184:187], v3, s[64:67], 0 offen sc1
  v_cvt_pk_bf16_f32 v81, v18, v19
  v_mfma_f32_16x16x32_bf16 v[28:31], a[216:219], a[152:155], v[28:31]
  v_exp_f32 v26, v26
  v_mfma_f32_16x16x32_bf16 v[36:39], a[216:219], a[168:171], v[36:39]
  v_exp_f32 v27, v27
  v_mfma_f32_16x16x32_bf16 v[44:47], a[216:219], a[184:187], v[44:47]
  v_cvt_pk_bf16_f32 v84, v24, v25
  v_cvt_pk_bf16_f32 v85, v26, v27
  s_waitcnt vmcnt(7)
  v_mfma_f32_16x16x32_bf16 v[20:23], a[220:223], a[140:143], v[20:23]
  buffer_load_dwordx4 v[188:191], v232, s[64:67], 0 offen sc1
  s_nop 0
  v_mfma_f32_16x16x32_bf16 v[28:31], a[220:223], a[156:159], v[28:31]
  v_exp_f32 v32, v32
  v_mfma_f32_16x16x32_bf16 v[36:39], a[220:223], a[172:175], v[36:39]
  v_exp_f32 v33, v33
  v_mfma_f32_16x16x32_bf16 v[44:47], a[220:223], a[188:191], v[44:47]
  v_exp_f32 v34, v34
  v_exp_f32 v20, v20
  v_exp_f32 v21, v21
  v_exp_f32 v22, v22
  v_exp_f32 v23, v23
  v_cvt_pk_bf16_f32 v82, v20, v21
  v_cvt_pk_bf16_f32 v83, v22, v23
  s_waitcnt vmcnt(6)
  v_cvt_scalef32_pk_bf16_fp4 v112, v176, 2.0 op_sel:[0,0,0]
  v_cvt_scalef32_pk_bf16_fp4 v113, v176, 2.0 op_sel:[1,0,0]
  v_cvt_scalef32_pk_bf16_fp4 v114, v176, 2.0 op_sel:[0,1,0]
  v_cvt_scalef32_pk_bf16_fp4 v115, v176, 2.0 op_sel:[1,1,0]
  v_exp_f32 v28, v28
  v_exp_f32 v29, v29
  v_mfma_f32_16x16x32_bf16 v[240:243], v[80:83], v[112:115], 0
  buffer_load_dwordx4 a[240:243], v2, s[64:67], 0 offen offset:0 sc1
  v_cvt_pk_bf16_f32 v86, v28, v29
  v_exp_f32 v30, v30
  v_exp_f32 v31, v31
  s_nop 0
  v_cvt_pk_bf16_f32 v87, v30, v31
  v_cvt_scalef32_pk_bf16_fp4 v116, v177, 2.0 op_sel:[0,0,0]
  v_cvt_scalef32_pk_bf16_fp4 v117, v177, 2.0 op_sel:[1,0,0]
  v_mfma_f32_16x16x32_bf16 a[32:35], v[84:87], v[112:115], 0
  v_cvt_scalef32_pk_bf16_fp4 v118, v177, 2.0 op_sel:[0,1,0]
  v_cvt_scalef32_pk_bf16_fp4 v119, v177, 2.0 op_sel:[1,1,0]
  v_cvt_scalef32_pk_bf16_fp4 v120, v178, 2.0 op_sel:[0,0,0]
  v_cvt_scalef32_pk_bf16_fp4 v121, v178, 2.0 op_sel:[1,0,0]
  v_mfma_f32_16x16x32_bf16 a[36:39], v[84:87], v[116:119], 0
  v_cvt_scalef32_pk_bf16_fp4 v122, v178, 2.0 op_sel:[0,1,0]
  v_cvt_scalef32_pk_bf16_fp4 v123, v178, 2.0 op_sel:[1,1,0]
  v_cvt_scalef32_pk_bf16_fp4 v136, v182, 2.0 op_sel:[0,0,0]
  v_cvt_scalef32_pk_bf16_fp4 v137, v182, 2.0 op_sel:[1,0,0]
  v_mfma_f32_16x16x32_bf16 v[248:251], v[80:83], v[120:123], 0
  v_cvt_scalef32_pk_bf16_fp4 v138, v182, 2.0 op_sel:[0,1,0]
  v_cvt_scalef32_pk_bf16_fp4 v139, v182, 2.0 op_sel:[1,1,0]
  v_cvt_scalef32_pk_bf16_fp4 v124, v179, 2.0 op_sel:[0,0,0]
  v_cvt_scalef32_pk_bf16_fp4 v125, v179, 2.0 op_sel:[1,0,0]
  v_mfma_f32_16x16x32_bf16 a[24:27], v[80:83], v[136:139], 0
  buffer_load_dwordx4 a[244:247], v2, s[64:67], 0 offen offset:1024 sc1
  v_cvt_scalef32_pk_bf16_fp4 v126, v179, 2.0 op_sel:[0,1,0]
  v_mfma_f32_16x16x32_bf16 a[56:59], v[84:87], v[136:139], 0
  v_cvt_scalef32_pk_bf16_fp4 v127, v179, 2.0 op_sel:[1,1,0]
  v_cvt_scalef32_pk_bf16_fp4 v132, v181, 2.0 op_sel:[0,0,0]
  v_mfma_f32_16x16x32_bf16 v[244:247], v[80:83], v[116:119], 0
  v_cvt_scalef32_pk_bf16_fp4 v133, v181, 2.0 op_sel:[1,0,0]
  v_cvt_scalef32_pk_bf16_fp4 v134, v181, 2.0 op_sel:[0,1,0]
  v_mfma_f32_16x16x32_bf16 a[40:43], v[84:87], v[120:123], 0
  v_cvt_scalef32_pk_bf16_fp4 v135, v181, 2.0 op_sel:[1,1,0]
  v_cvt_scalef32_pk_bf16_fp4 v128, v180, 2.0 op_sel:[0,0,0]
  v_mfma_f32_16x16x32_bf16 v[252:255], v[80:83], v[124:127], 0
  buffer_load_dwordx4 a[248:251], v2, s[64:67], 0 offen offset:2048 sc1
  v_cvt_scalef32_pk_bf16_fp4 v129, v180, 2.0 op_sel:[1,0,0]
  v_mfma_f32_16x16x32_bf16 a[44:47], v[84:87], v[124:127], 0
  v_cvt_scalef32_pk_bf16_fp4 v130, v180, 2.0 op_sel:[0,1,0]
  v_cvt_scalef32_pk_bf16_fp4 v131, v180, 2.0 op_sel:[1,1,0]
  v_mfma_f32_16x16x32_bf16 a[20:23], v[80:83], v[132:135], 0
  v_cvt_scalef32_pk_bf16_fp4 v140, v183, 2.0 op_sel:[0,0,0]
  v_cvt_scalef32_pk_bf16_fp4 v141, v183, 2.0 op_sel:[1,0,0]
  v_mfma_f32_16x16x32_bf16 a[48:51], v[84:87], v[128:131], 0
  v_cvt_scalef32_pk_bf16_fp4 v142, v183, 2.0 op_sel:[0,1,0]
  v_cvt_scalef32_pk_bf16_fp4 v143, v183, 2.0 op_sel:[1,1,0]
  v_mfma_f32_16x16x32_bf16 a[52:55], v[84:87], v[132:135], 0
  buffer_load_dwordx4 a[252:255], v2, s[64:67], 0 offen offset:3072 sc1
  v_cvt_pk_bf16_f32 v88, v32, v33
  v_mfma_f32_16x16x32_bf16 a[60:63], v[84:87], v[140:143], 0
  s_waitcnt lgkmcnt(5)
  v_exp_f32 v35, v35
  v_mfma_f32_16x16x32_bf16 v[224:227], v[80:83], a[0:3], 0
  s_xor_b32 s64, s43, 0xc000
  v_exp_f32 v36, v36
  v_mfma_f32_16x16x32_bf16 a[28:31], v[80:83], v[140:143], 0
  s_waitcnt vmcnt(9) lgkmcnt(3)
  v_exp_f32 v37, v37
  v_mfma_f32_16x16x32_bf16 v[48:51], a[224:227], a[128:131], v[200:203]
  buffer_load_dwordx4 a[192:195], v1, s[60:63], 0 offen offset:0 sc1
  v_cvt_pk_bf16_f32 v89, v34, v35
  v_mfma_f32_16x16x32_bf16 a[16:19], v[80:83], v[128:131], 0
  v_exp_f32 v38, v38
  v_mfma_f32_16x16x32_bf16 v[56:59], a[224:227], a[144:147], v[200:203]
  v_exp_f32 v39, v39
  v_mfma_f32_16x16x32_bf16 v[64:67], a[224:227], a[160:163], v[200:203]
  v_cvt_pk_bf16_f32 v90, v36, v37
  v_cvt_pk_bf16_f32 v91, v38, v39
  v_mfma_f32_16x16x32_bf16 v[72:75], a[224:227], a[176:179], v[200:203]
  s_waitcnt vmcnt(9)
  v_exp_f32 v40, v40
  v_mfma_f32_16x16x32_bf16 v[48:51], a[228:231], a[132:135], v[48:51]
  buffer_load_dwordx4 a[196:199], v1, s[60:63], 0 offen offset:1024 sc1
  ds_read_b128 v[200:203], v4 offset:384
  v_mfma_f32_16x16x32_bf16 v[56:59], a[228:231], a[148:151], v[56:59]
  v_exp_f32 v41, v41
  v_mfma_f32_16x16x32_bf16 v[64:67], a[228:231], a[164:167], v[64:67]
  v_exp_f32 v42, v42
  v_mfma_f32_16x16x32_bf16 v[72:75], a[228:231], a[180:183], v[72:75]
  s_waitcnt vmcnt(9)
  v_exp_f32 v43, v43
  v_mfma_f32_16x16x32_bf16 v[48:51], a[232:235], a[136:139], v[48:51]
  buffer_load_dwordx4 a[200:203], v1, s[60:63], 0 offen offset:2048 sc1
  v_cvt_pk_bf16_f32 v92, v40, v41
  v_mfma_f32_16x16x32_bf16 v[8:11], v[84:87], a[0:3], 0
  v_exp_f32 v44, v44
  v_mfma_f32_16x16x32_bf16 v[56:59], a[232:235], a[152:155], v[56:59]
  v_exp_f32 v45, v45
  v_mfma_f32_16x16x32_bf16 v[64:67], a[232:235], a[168:171], v[64:67]
  v_exp_f32 v46, v46
  v_mfma_f32_16x16x32_bf16 v[72:75], a[232:235], a[184:187], v[72:75]
  s_waitcnt vmcnt(9)
  v_exp_f32 v47, v47
  v_mfma_f32_16x16x32_bf16 v[56:59], a[236:239], a[156:159], v[56:59]
  buffer_load_dwordx4 a[204:207], v1, s[60:63], 0 offen offset:3072 sc1
  v_cvt_pk_bf16_f32 v93, v42, v43
  v_mfma_f32_16x16x32_bf16 v[64:67], a[236:239], a[172:175], v[64:67]
  v_cvt_pk_bf16_f32 v94, v44, v45
  v_cvt_pk_bf16_f32 v95, v46, v47
  v_mfma_f32_16x16x32_bf16 v[48:51], a[236:239], a[140:143], v[48:51]
  s_waitcnt vmcnt(8)
  v_cvt_scalef32_pk_bf16_fp4 v144, v184, 2.0 op_sel:[0,0,0]
  v_cvt_scalef32_pk_bf16_fp4 v145, v184, 2.0 op_sel:[1,0,0]
  v_mfma_f32_16x16x32_bf16 v[72:75], a[236:239], a[188:191], v[72:75]
  s_waitcnt vmcnt(7)
  v_exp_f32 v56, v56
  v_mfma_f32_16x16x32_bf16 v[52:55], a[240:243], a[128:131], v[204:207]
  buffer_load_dwordx4 a[208:211], v2, s[60:63], 0 offen offset:0 sc1
  v_cvt_scalef32_pk_bf16_fp4 v146, v184, 2.0 op_sel:[0,1,0]
  v_mfma_f32_16x16x32_bf16 v[60:63], a[240:243], a[144:147], v[204:207]
  v_exp_f32 v57, v57
  v_mfma_f32_16x16x32_bf16 v[68:71], a[240:243], a[160:163], v[204:207]
  v_exp_f32 v58, v58
  v_mfma_f32_16x16x32_bf16 v[76:79], a[240:243], a[176:179], v[204:207]
  s_waitcnt vmcnt(7)
  v_exp_f32 v59, v59
  v_mfma_f32_16x16x32_bf16 v[52:55], a[244:247], a[132:135], v[52:55]
  buffer_load_dwordx4 a[212:215], v2, s[60:63], 0 offen offset:1024 sc1
  ds_read_b128 v[204:207], v4 offset:448
  v_mfma_f32_16x16x32_bf16 v[76:79], a[244:247], a[180:183], v[76:79]
  s_waitcnt vmcnt(7)
  v_cvt_pk_bf16_f32 v100, v56, v57
  v_cvt_pk_bf16_f32 v101, v58, v59
  v_mfma_f32_16x16x32_bf16 v[52:55], a[248:251], a[136:139], v[52:55]
  v_cvt_scalef32_pk_bf16_fp4 v147, v184, 2.0 op_sel:[1,1,0]
  v_cvt_scalef32_pk_bf16_fp4 v164, v189, 2.0 op_sel:[0,0,0]
  v_mfma_f32_16x16x32_bf16 a[84:87], v[88:91], v[132:135], 0
  v_cvt_scalef32_pk_bf16_fp4 v165, v189, 2.0 op_sel:[1,0,0]
  v_cvt_scalef32_pk_bf16_fp4 v166, v189, 2.0 op_sel:[0,1,0]
  v_mfma_f32_16x16x32_bf16 v[60:63], a[244:247], a[148:151], v[60:63]
  buffer_load_dwordx4 a[216:219], v2, s[60:63], 0 offen offset:2048 sc1
  v_cvt_scalef32_pk_bf16_fp4 v167, v189, 2.0 op_sel:[1,1,0]
  v_mfma_f32_16x16x32_bf16 v[68:71], a[244:247], a[164:167], v[68:71]
  v_exp_f32 v48, v48
  v_mfma_f32_16x16x32_bf16 v[60:63], a[248:251], a[152:155], v[60:63]
  v_exp_f32 v49, v49
  v_mfma_f32_16x16x32_bf16 v[68:71], a[248:251], a[168:171], v[68:71]
  v_exp_f32 v50, v50
  v_mfma_f32_16x16x32_bf16 v[76:79], a[248:251], a[184:187], v[76:79]
  s_waitcnt vmcnt(7)
  v_exp_f32 v51, v51
  v_mfma_f32_16x16x32_bf16 v[60:63], a[252:255], a[156:159], v[60:63]
  buffer_load_dwordx4 a[220:223], v2, s[60:63], 0 offen offset:3072 sc1
  v_cvt_pk_bf16_f32 v96, v48, v49
  v_mfma_f32_16x16x32_bf16 v[68:71], a[252:255], a[172:175], v[68:71]
  v_cvt_pk_bf16_f32 v97, v50, v51
  v_cvt_scalef32_pk_bf16_fp4 v168, v190, 2.0 op_sel:[0,0,0]
  v_mfma_f32_16x16x32_bf16 a[104:107], v[92:95], v[120:123], 0
  v_cvt_scalef32_pk_bf16_fp4 v169, v190, 2.0 op_sel:[1,0,0]
  v_cvt_scalef32_pk_bf16_fp4 v170, v190, 2.0 op_sel:[0,1,0]
  v_mfma_f32_16x16x32_bf16 v[76:79], a[252:255], a[188:191], v[76:79]
  v_exp_f32 v60, v60
  v_mfma_f32_16x16x32_bf16 v[208:211], v[88:91], v[112:115], 0
  buffer_load_dwordx4 a[224:227], v1, s[64:67], 0 offen offset:0 sc1
  v_cvt_scalef32_pk_bf16_fp4 v171, v190, 2.0 op_sel:[1,1,0]
  v_mfma_f32_16x16x32_bf16 a[96:99], v[92:95], v[112:115], 0
  v_exp_f32 v61, v61
  v_mfma_f32_16x16x32_bf16 a[108:111], v[92:95], v[124:127], 0
  v_exp_f32 v62, v62
  v_mfma_f32_16x16x32_bf16 v[220:223], v[88:91], v[124:127], 0
  v_exp_f32 v63, v63
  v_mfma_f32_16x16x32_bf16 a[80:83], v[88:91], v[128:131], 0
  buffer_load_dwordx4 a[228:231], v1, s[64:67], 0 offen offset:1024 sc1
  v_cvt_pk_bf16_f32 v102, v60, v61
  v_mfma_f32_16x16x32_bf16 a[112:115], v[92:95], v[128:131], 0
  v_cvt_pk_bf16_f32 v103, v62, v63
  v_cvt_scalef32_pk_bf16_fp4 v172, v191, 2.0 op_sel:[0,0,0]
  v_mfma_f32_16x16x32_bf16 v[236:239], v[92:95], a[0:3], 0
  s_waitcnt vmcnt(6) lgkmcnt(2)
  v_cvt_scalef32_pk_bf16_fp4 v173, v191, 2.0 op_sel:[1,0,0]
  v_cvt_scalef32_pk_bf16_fp4 v174, v191, 2.0 op_sel:[0,1,0]
  v_mfma_f32_16x16x32_bf16 v[16:19], a[192:195], a[128:131], v[192:195]
  v_cvt_scalef32_pk_bf16_fp4 v175, v191, 2.0 op_sel:[1,1,0]
  v_cvt_scalef32_pk_bf16_fp4 v148, v185, 2.0 op_sel:[0,0,0]
  v_mfma_f32_16x16x32_bf16 v[52:55], a[252:255], a[140:143], v[52:55]
  buffer_load_dwordx4 a[232:235], v1, s[64:67], 0 offen offset:2048 sc1
  v_cvt_scalef32_pk_bf16_fp4 v149, v185, 2.0 op_sel:[1,0,0]
  v_mfma_f32_16x16x32_bf16 v[24:27], a[192:195], a[144:147], v[192:195]
  v_cvt_scalef32_pk_bf16_fp4 v150, v185, 2.0 op_sel:[0,1,0]
  v_cvt_scalef32_pk_bf16_fp4 v151, v185, 2.0 op_sel:[1,1,0]
  v_mfma_f32_16x16x32_bf16 v[228:231], v[88:91], a[0:3], 0
  ds_read_b128 a[0:3], v5 offset:544
  v_cvt_scalef32_pk_bf16_fp4 v152, v186, 2.0 op_sel:[0,0,0]
  v_mfma_f32_16x16x32_bf16 a[116:119], v[92:95], v[132:135], 0
  v_exp_f32 v52, v52
  v_mfma_f32_16x16x32_bf16 a[88:91], v[88:91], v[136:139], 0
  buffer_load_dwordx4 a[236:239], v1, s[64:67], 0 offen offset:3072 sc1
  v_cvt_scalef32_pk_bf16_fp4 v153, v186, 2.0 op_sel:[1,0,0]
  v_mfma_f32_16x16x32_bf16 v[32:35], a[192:195], a[160:163], v[192:195]
  v_exp_f32 v53, v53
  v_mfma_f32_16x16x32_bf16 v[40:43], a[192:195], a[176:179], v[192:195]
  ds_read_b128 v[192:195], v4 offset:512
  v_cvt_pk_bf16_f32 v98, v52, v53
  v_mfma_f32_16x16x32_bf16 v[16:19], a[196:199], a[132:135], v[16:19]
  v_exp_f32 v54, v54
  v_mfma_f32_16x16x32_bf16 v[24:27], a[196:199], a[148:151], v[24:27]
  buffer_load_dwordx4 a[240:243], v2, s[64:67], 0 offen offset:0 sc1
  v_cvt_scalef32_pk_bf16_fp4 v154, v186, 2.0 op_sel:[0,1,0]
  v_mfma_f32_16x16x32_bf16 v[32:35], a[196:199], a[164:167], v[32:35]
  v_exp_f32 v55, v55
  v_mfma_f32_16x16x32_bf16 v[40:43], a[196:199], a[180:183], v[40:43]
  v_cvt_pk_bf16_f32 v99, v54, v55
  v_cvt_scalef32_pk_bf16_fp4 v155, v186, 2.0 op_sel:[1,1,0]
  v_mfma_f32_16x16x32_bf16 a[120:123], v[92:95], v[136:139], 0
  v_cvt_scalef32_pk_bf16_fp4 v160, v188, 2.0 op_sel:[0,0,0]
  v_cvt_scalef32_pk_bf16_fp4 v161, v188, 2.0 op_sel:[1,0,0]
  v_mfma_f32_16x16x32_bf16 a[92:95], v[88:91], v[140:143], 0
  buffer_load_dwordx4 a[244:247], v2, s[64:67], 0 offen offset:1024 sc1
  v_cvt_scalef32_pk_bf16_fp4 v162, v188, 2.0 op_sel:[0,1,0]
  v_mfma_f32_16x16x32_bf16 v[212:215], v[88:91], v[116:119], 0
  v_cvt_scalef32_pk_bf16_fp4 v163, v188, 2.0 op_sel:[1,1,0]
  v_cvt_scalef32_pk_bf16_fp4 v156, v187, 2.0 op_sel:[0,0,0]
  v_mfma_f32_16x16x32_bf16 v[16:19], a[200:203], a[136:139], v[16:19]
  v_cvt_scalef32_pk_bf16_fp4 v157, v187, 2.0 op_sel:[1,0,0]
  v_cvt_scalef32_pk_bf16_fp4 v158, v187, 2.0 op_sel:[0,1,0]
  v_mfma_f32_16x16x32_bf16 v[24:27], a[200:203], a[152:155], v[24:27]
  v_exp_f32 v64, v64
  v_mfma_f32_16x16x32_bf16 v[32:35], a[200:203], a[168:171], v[32:35]
  buffer_load_dwordx4 a[248:251], v2, s[64:67], 0 offen offset:2048 sc1
  v_cvt_scalef32_pk_bf16_fp4 v159, v187, 2.0 op_sel:[1,1,0]
  v_mfma_f32_16x16x32_bf16 v[40:43], a[200:203], a[184:187], v[40:43]
  v_exp_f32 v65, v65
  v_mfma_f32_16x16x32_bf16 v[24:27], a[204:207], a[156:159], v[24:27]
  v_exp_f32 v66, v66
  v_mfma_f32_16x16x32_bf16 v[16:19], a[204:207], a[140:143], v[16:19]
  s_waitcnt vmcnt(7)
  v_exp_f32 v67, v67
  v_mfma_f32_16x16x32_bf16 v[36:39], a[208:211], a[160:163], v[196:199]
  buffer_load_dwordx4 a[252:255], v2, s[64:67], 0 offen offset:3072 sc1
  v_cvt_pk_bf16_f32 v104, v64, v65
  v_mfma_f32_16x16x32_bf16 v[28:31], a[208:211], a[144:147], v[196:199]
  v_exp_f32 v68, v68
  v_mfma_f32_16x16x32_bf16 a[100:103], v[92:95], v[116:119], 0
  v_exp_f32 v69, v69
  v_mfma_f32_16x16x32_bf16 v[216:219], v[88:91], v[120:123], 0
  v_exp_f32 v70, v70
  v_mfma_f32_16x16x32_bf16 a[124:127], v[92:95], v[140:143], 0
  buffer_load_dwordx4 v[176:179], v3, s[60:63], 0 offen sc1
  v_cvt_pk_bf16_f32 v105, v66, v67
  v_mfma_f32_16x16x32_bf16 v[32:35], a[204:207], a[172:175], v[32:35]
  v_exp_f32 v71, v71
  v_mfma_f32_16x16x32_bf16 v[20:23], a[208:211], a[128:131], v[196:199]
  v_cvt_pk_bf16_f32 v106, v68, v69
  v_cvt_pk_bf16_f32 v107, v70, v71
  v_mfma_f32_16x16x32_bf16 v[44:47], a[208:211], a[176:179], v[196:199]
  v_exp_f32 v72, v72
  v_mfma_f32_16x16x32_bf16 v[20:23], a[212:215], a[132:135], v[20:23]
  buffer_load_dwordx4 v[180:183], v232, s[60:63], 0 offen sc1
  ds_read_b128 v[196:199], v4 offset:576
  v_mfma_f32_16x16x32_bf16 v[28:31], a[212:215], a[148:151], v[28:31]
  s_xor_b32 s60, s43, 0x10000
  v_exp_f32 v73, v73
  v_mfma_f32_16x16x32_bf16 v[36:39], a[212:215], a[164:167], v[36:39]
  v_exp_f32 v74, v74
  v_mfma_f32_16x16x32_bf16 v[44:47], a[212:215], a[180:183], v[44:47]
  v_exp_f32 v75, v75
  v_mfma_f32_16x16x32_bf16 v[20:23], a[216:219], a[136:139], v[20:23]
  buffer_load_dwordx4 a[192:195], v1, s[60:63], 0 offen offset:0 sc1
  v_cvt_pk_bf16_f32 v108, v72, v73
  v_mfma_f32_16x16x32_bf16 v[28:31], a[216:219], a[152:155], v[28:31]
  v_exp_f32 v76, v76
  v_mfma_f32_16x16x32_bf16 v[36:39], a[216:219], a[168:171], v[36:39]
  v_exp_f32 v77, v77
  v_mfma_f32_16x16x32_bf16 v[44:47], a[216:219], a[184:187], v[44:47]
  v_exp_f32 v78, v78
  v_mfma_f32_16x16x32_bf16 v[20:23], a[220:223], a[140:143], v[20:23]
  buffer_load_dwordx4 a[196:199], v1, s[60:63], 0 offen offset:1024 sc1
  v_cvt_pk_bf16_f32 v109, v74, v75
  v_mfma_f32_16x16x32_bf16 v[28:31], a[220:223], a[156:159], v[28:31]
  v_exp_f32 v79, v79
  v_mfma_f32_16x16x32_bf16 a[32:35], v[100:103], v[144:147], a[32:35]
  v_cvt_pk_bf16_f32 v110, v76, v77
  v_cvt_pk_bf16_f32 v111, v78, v79
  v_mfma_f32_16x16x32_bf16 v[36:39], a[220:223], a[172:175], v[36:39]
  v_exp_f32 v16, v16
  v_mfma_f32_16x16x32_bf16 v[44:47], a[220:223], a[188:191], v[44:47]
  buffer_load_dwordx4 a[200:203], v1, s[60:63], 0 offen offset:2048 sc1
  s_nop 0
  v_mfma_f32_16x16x32_bf16 a[52:55], v[100:103], v[164:167], a[52:55]
  v_exp_f32 v17, v17
  v_mfma_f32_16x16x32_bf16 a[24:27], v[96:99], v[168:171], a[24:27]
  v_exp_f32 v18, v18
  v_mfma_f32_16x16x32_bf16 a[28:31], v[96:99], v[172:175], a[28:31]
  v_exp_f32 v19, v19
  v_mfma_f32_16x16x32_bf16 v[40:43], a[204:207], a[188:191], v[40:43]
  buffer_load_dwordx4 a[204:207], v1, s[60:63], 0 offen offset:3072 sc1
  v_cvt_pk_bf16_f32 v80, v16, v17
  v_mfma_f32_16x16x32_bf16 v[240:243], v[96:99], v[144:147], v[240:243]
  v_exp_f32 v20, v20
  v_mfma_f32_16x16x32_bf16 v[244:247], v[96:99], v[148:151], v[244:247]
  v_exp_f32 v21, v21
  v_mfma_f32_16x16x32_bf16 a[36:39], v[100:103], v[148:151], a[36:39]
  v_exp_f32 v22, v22
  v_mfma_f32_16x16x32_bf16 v[248:251], v[96:99], v[152:155], v[248:251]
  buffer_load_dwordx4 a[208:211], v2, s[60:63], 0 offen offset:0 sc1
  v_cvt_pk_bf16_f32 v81, v18, v19
  v_mfma_f32_16x16x32_bf16 a[48:51], v[100:103], v[160:163], a[48:51]
  v_exp_f32 v23, v23
  v_mfma_f32_16x16x32_bf16 v[252:255], v[96:99], v[156:159], v[252:255]
  v_cvt_pk_bf16_f32 v82, v20, v21
  v_cvt_pk_bf16_f32 v83, v22, v23
  v_mfma_f32_16x16x32_bf16 a[16:19], v[96:99], v[160:163], a[16:19]
  v_exp_f32 v24, v24
  v_mfma_f32_16x16x32_bf16 v[224:227], v[96:99], a[4:7], v[224:227]
  buffer_load_dwordx4 a[212:215], v2, s[60:63], 0 offen offset:1024 sc1
  v_mfma_f32_16x16x32_bf16 v[8:11], v[100:103], a[4:7], v[8:11]
  s_waitcnt vmcnt(12) lgkmcnt(3)
  v_exp_f32 v25, v25
  v_mfma_f32_16x16x32_bf16 v[48:51], a[224:227], a[128:131], v[200:203]
  s_waitcnt vmcnt(6)
  v_cvt_scalef32_pk_bf16_fp4 v112, v176, 2.0 op_sel:[0,0,0]
  v_cvt_scalef32_pk_bf16_fp4 v113, v176, 2.0 op_sel:[1,0,0]
  v_mfma_f32_16x16x32_bf16 a[60:63], v[100:103], v[172:175], a[60:63]
  v_cvt_scalef32_pk_bf16_fp4 v114, v176, 2.0 op_sel:[0,1,0]
  v_cvt_scalef32_pk_bf16_fp4 v115, v176, 2.0 op_sel:[1,1,0]
  v_mfma_f32_16x16x32_bf16 a[40:43], v[100:103], v[152:155], a[40:43]
  buffer_load_dwordx4 a[216:219], v2, s[60:63], 0 offen offset:2048 sc1
  v_cvt_pk_bf16_f32 v84, v24, v25
  v_mfma_f32_16x16x32_bf16 v[208:211], v[104:107], v[144:147], v[208:211]
  v_exp_f32 v26, v26
  v_mfma_f32_16x16x32_bf16 a[96:99], v[108:111], v[144:147], a[96:99]
  v_exp_f32 v27, v27
  v_mfma_f32_16x16x32_bf16 a[56:59], v[100:103], v[168:171], a[56:59]
  v_exp_f32 v28, v28
  v_mfma_f32_16x16x32_bf16 v[212:215], v[104:107], v[148:151], v[212:215]
  buffer_load_dwordx4 a[220:223], v2, s[60:63], 0 offen offset:3072 sc1
  v_cvt_pk_bf16_f32 v85, v26, v27
  v_mfma_f32_16x16x32_bf16 a[100:103], v[108:111], v[148:151], a[100:103]
  v_exp_f32 v29, v29
  v_mfma_f32_16x16x32_bf16 a[20:23], v[96:99], v[164:167], a[20:23]
  v_exp_f32 v30, v30
  v_mfma_f32_16x16x32_bf16 a[44:47], v[100:103], v[156:159], a[44:47]
  v_exp_f32 v31, v31
  v_mfma_f32_16x16x32_bf16 v[56:59], a[224:227], a[144:147], v[200:203]
  buffer_load_dwordx4 v[184:187], v3, s[64:67], 0 offen sc1
  v_cvt_pk_bf16_f32 v86, v28, v29
  v_mfma_f32_16x16x32_bf16 v[48:51], a[228:231], a[132:135], v[48:51]
  v_cvt_pk_bf16_f32 v87, v30, v31
  v_cvt_scalef32_pk_bf16_fp4 v116, v177, 2.0 op_sel:[0,0,0]
  v_mfma_f32_16x16x32_bf16 v[56:59], a[228:231], a[148:151], v[56:59]
  v_cvt_scalef32_pk_bf16_fp4 v117, v177, 2.0 op_sel:[1,0,0]
  v_cvt_scalef32_pk_bf16_fp4 v118, v177, 2.0 op_sel:[0,1,0]
  v_mfma_f32_16x16x32_bf16 v[48:51], a[232:235], a[136:139], v[48:51]
  v_cvt_scalef32_pk_bf16_fp4 v119, v177, 2.0 op_sel:[1,1,0]
  v_cvt_scalef32_pk_bf16_fp4 v120, v178, 2.0 op_sel:[0,0,0]
  v_mfma_f32_16x16x32_bf16 v[56:59], a[232:235], a[152:155], v[56:59]
  buffer_load_dwordx4 v[188:191], v232, s[64:67], 0 offen sc1
  v_cvt_scalef32_pk_bf16_fp4 v121, v178, 2.0 op_sel:[1,0,0]
  v_mfma_f32_16x16x32_bf16 v[48:51], a[236:239], a[140:143], v[48:51]
  s_xor_b32 s64, s43, 0x14000
  v_cvt_scalef32_pk_bf16_fp4 v122, v178, 2.0 op_sel:[0,1,0]
  v_cvt_scalef32_pk_bf16_fp4 v123, v178, 2.0 op_sel:[1,1,0]
  v_mfma_f32_16x16x32_bf16 v[56:59], a[236:239], a[156:159], v[56:59]
  v_cvt_scalef32_pk_bf16_fp4 v124, v179, 2.0 op_sel:[0,0,0]
  v_cvt_scalef32_pk_bf16_fp4 v125, v179, 2.0 op_sel:[1,0,0]
  v_mfma_f32_16x16x32_bf16 v[52:55], a[240:243], a[128:131], v[204:207]
  v_cvt_scalef32_pk_bf16_fp4 v126, v179, 2.0 op_sel:[0,1,0]
  v_cvt_scalef32_pk_bf16_fp4 v127, v179, 2.0 op_sel:[1,1,0]
  v_mfma_f32_16x16x32_bf16 v[220:223], v[104:107], v[156:159], v[220:223]
  buffer_load_dwordx4 v[176:179], v3, s[60:63], 0 offen sc1
  v_cvt_scalef32_pk_bf16_fp4 v128, v180, 2.0 op_sel:[0,0,0]
  v_mfma_f32_16x16x32_bf16 a[108:111], v[108:111], v[156:159], a[108:111]
  v_cvt_scalef32_pk_bf16_fp4 v129, v180, 2.0 op_sel:[1,0,0]
  v_cvt_scalef32_pk_bf16_fp4 v130, v180, 2.0 op_sel:[0,1,0]
  v_mfma_f32_16x16x32_bf16 a[80:83], v[104:107], v[160:163], a[80:83]
  v_cvt_scalef32_pk_bf16_fp4 v131, v180, 2.0 op_sel:[1,1,0]
  v_cvt_scalef32_pk_bf16_fp4 v132, v181, 2.0 op_sel:[0,0,0]
  v_mfma_f32_16x16x32_bf16 a[120:123], v[108:111], v[168:171], a[120:123]
  v_cvt_scalef32_pk_bf16_fp4 v133, v181, 2.0 op_sel:[1,0,0]
  v_cvt_scalef32_pk_bf16_fp4 v134, v181, 2.0 op_sel:[0,1,0]
  v_mfma_f32_16x16x32_bf16 v[60:63], a[240:243], a[144:147], v[204:207]
  v_cvt_scalef32_pk_bf16_fp4 v135, v181, 2.0 op_sel:[1,1,0]
  v_cvt_scalef32_pk_bf16_fp4 v136, v182, 2.0 op_sel:[0,0,0]
  v_mfma_f32_16x16x32_bf16 v[52:55], a[244:247], a[132:135], v[52:55]
  v_cvt_scalef32_pk_bf16_fp4 v137, v182, 2.0 op_sel:[1,0,0]
  v_cvt_scalef32_pk_bf16_fp4 v138, v182, 2.0 op_sel:[0,1,0]
  v_mfma_f32_16x16x32_bf16 v[60:63], a[244:247], a[148:151], v[60:63]
  v_cvt_scalef32_pk_bf16_fp4 v139, v182, 2.0 op_sel:[1,1,0]
  v_cvt_scalef32_pk_bf16_fp4 v140, v183, 2.0 op_sel:[0,0,0]
  v_mfma_f32_16x16x32_bf16 v[52:55], a[248:251], a[136:139], v[52:55]
  v_cvt_scalef32_pk_bf16_fp4 v141, v183, 2.0 op_sel:[1,0,0]
  v_cvt_scalef32_pk_bf16_fp4 v142, v183, 2.0 op_sel:[0,1,0]
  v_mfma_f32_16x16x32_bf16 v[60:63], a[248:251], a[152:155], v[60:63]
  v_exp_f32 v32, v32
  v_mfma_f32_16x16x32_bf16 v[52:55], a[252:255], a[140:143], v[52:55]
  v_exp_f32 v33, v33
  v_mfma_f32_16x16x32_bf16 v[216:219], v[104:107], v[152:155], v[216:219]
  v_cvt_scalef32_pk_bf16_fp4 v143, v183, 2.0 op_sel:[1,1,0]
  v_cvt_pk_bf16_f32 v88, v32, v33
  v_mfma_f32_16x16x32_bf16 a[104:107], v[108:111], v[152:155], a[104:107]
  v_exp_f32 v34, v34
  v_mfma_f32_16x16x32_bf16 a[92:95], v[104:107], v[172:175], a[92:95]
  v_exp_f32 v35, v35
  v_mfma_f32_16x16x32_bf16 a[124:127], v[108:111], v[172:175], a[124:127]
  buffer_load_dwordx4 v[180:183], v232, s[60:63], 0 offen sc1
  v_cvt_pk_bf16_f32 v89, v34, v35
  v_mfma_f32_16x16x32_bf16 v[228:231], v[104:107], a[4:7], v[228:231]
  s_xor_b32 s60, s43, 0x18000
  v_exp_f32 v36, v36
  v_mfma_f32_16x16x32_bf16 v[236:239], v[108:111], a[4:7], v[236:239]
  v_exp_f32 v37, v37
  v_mfma_f32_16x16x32_bf16 v[64:67], a[224:227], a[160:163], v[200:203]
  ds_read_b128 a[4:7], v5 offset:816
  v_cvt_pk_bf16_f32 v90, v36, v37
  v_mfma_f32_16x16x32_bf16 v[72:75], a[224:227], a[176:179], v[200:203]
  buffer_load_dwordx4 a[224:227], v1, s[64:67], 0 offen offset:0 sc1
  ds_read_b128 v[200:203], v4 offset:640
  v_mfma_f32_16x16x32_bf16 v[64:67], a[228:231], a[164:167], v[64:67]
  v_exp_f32 v38, v38
  v_mfma_f32_16x16x32_bf16 v[72:75], a[228:231], a[180:183], v[72:75]
  v_exp_f32 v39, v39
  v_mfma_f32_16x16x32_bf16 v[64:67], a[232:235], a[168:171], v[64:67]
  v_exp_f32 v40, v40
  v_mfma_f32_16x16x32_bf16 v[72:75], a[232:235], a[184:187], v[72:75]
  buffer_load_dwordx4 a[228:231], v1, s[64:67], 0 offen offset:1024 sc1
  v_cvt_pk_bf16_f32 v91, v38, v39
  v_mfma_f32_16x16x32_bf16 v[60:63], a[252:255], a[156:159], v[60:63]
  v_exp_f32 v41, v41
  v_mfma_f32_16x16x32_bf16 v[64:67], a[236:239], a[172:175], v[64:67]
  v_exp_f32 v42, v42
  v_mfma_f32_16x16x32_bf16 v[72:75], a[236:239], a[188:191], v[72:75]
  v_exp_f32 v43, v43
  v_mfma_f32_16x16x32_bf16 v[68:71], a[240:243], a[160:163], v[204:207]
  buffer_load_dwordx4 a[232:235], v1, s[64:67], 0 offen offset:2048 sc1
  v_cvt_pk_bf16_f32 v92, v40, v41
  v_mfma_f32_16x16x32_bf16 v[76:79], a[240:243], a[176:179], v[204:207]
  ds_read_b128 v[204:207], v4 offset:704
  v_cvt_pk_bf16_f32 v93, v42, v43
  v_mfma_f32_16x16x32_bf16 a[112:115], v[108:111], v[160:163], a[112:115]
  v_exp_f32 v44, v44
  v_mfma_f32_16x16x32_bf16 a[84:87], v[104:107], v[164:167], a[84:87]
  v_exp_f32 v45, v45
  v_mfma_f32_16x16x32_bf16 a[116:119], v[108:111], v[164:167], a[116:119]
  buffer_load_dwordx4 a[236:239], v1, s[64:67], 0 offen offset:3072 sc1
  v_cvt_pk_bf16_f32 v94, v44, v45
  v_mfma_f32_16x16x32_bf16 a[88:91], v[104:107], v[168:171], a[88:91]
  v_exp_f32 v46, v46
  v_mfma_f32_16x16x32_bf16 v[68:71], a[244:247], a[164:167], v[68:71]
  v_exp_f32 v47, v47
  v_mfma_f32_16x16x32_bf16 v[76:79], a[244:247], a[180:183], v[76:79]
  v_exp_f32 v48, v48
  v_mfma_f32_16x16x32_bf16 v[68:71], a[248:251], a[168:171], v[68:71]
  buffer_load_dwordx4 a[240:243], v2, s[64:67], 0 offen offset:0 sc1
  v_cvt_pk_bf16_f32 v95, v46, v47
  v_mfma_f32_16x16x32_bf16 v[76:79], a[248:251], a[184:187], v[76:79]
  v_exp_f32 v49, v49
  v_mfma_f32_16x16x32_bf16 v[68:71], a[252:255], a[172:175], v[68:71]
  v_exp_f32 v50, v50
  v_mfma_f32_16x16x32_bf16 v[76:79], a[252:255], a[188:191], v[76:79]
  v_exp_f32 v51, v51
  v_mfma_f32_16x16x32_bf16 v[240:243], v[80:83], v[112:115], v[240:243]
  buffer_load_dwordx4 a[244:247], v2, s[64:67], 0 offen offset:1024 sc1
  v_cvt_pk_bf16_f32 v96, v48, v49
  v_mfma_f32_16x16x32_bf16 a[32:35], v[84:87], v[112:115], a[32:35]
  s_waitcnt vmcnt(8)
  v_exp_f32 v52, v52
  v_mfma_f32_16x16x32_bf16 v[244:247], v[80:83], v[116:119], v[244:247]
  v_exp_f32 v53, v53
  v_mfma_f32_16x16x32_bf16 a[36:39], v[84:87], v[116:119], a[36:39]
  v_exp_f32 v54, v54
  v_mfma_f32_16x16x32_bf16 v[248:251], v[80:83], v[120:123], v[248:251]
  buffer_load_dwordx4 a[248:251], v2, s[64:67], 0 offen offset:2048 sc1
  v_cvt_pk_bf16_f32 v97, v50, v51
  v_mfma_f32_16x16x32_bf16 a[40:43], v[84:87], v[120:123], a[40:43]
  v_exp_f32 v55, v55
  v_mfma_f32_16x16x32_bf16 v[252:255], v[80:83], v[124:127], v[252:255]
  v_cvt_pk_bf16_f32 v98, v52, v53
  v_cvt_pk_bf16_f32 v99, v54, v55
  v_mfma_f32_16x16x32_bf16 a[44:47], v[84:87], v[124:127], a[44:47]
  v_cvt_scalef32_pk_bf16_fp4 v144, v184, 2.0 op_sel:[0,0,0]
  v_cvt_scalef32_pk_bf16_fp4 v145, v184, 2.0 op_sel:[1,0,0]
  v_mfma_f32_16x16x32_bf16 a[16:19], v[80:83], v[128:131], a[16:19]
  buffer_load_dwordx4 a[252:255], v2, s[64:67], 0 offen offset:3072 sc1
  v_cvt_scalef32_pk_bf16_fp4 v146, v184, 2.0 op_sel:[0,1,0]
  v_mfma_f32_16x16x32_bf16 a[48:51], v[84:87], v[128:131], a[48:51]
  v_cvt_scalef32_pk_bf16_fp4 v147, v184, 2.0 op_sel:[1,1,0]
  v_cvt_scalef32_pk_bf16_fp4 v148, v185, 2.0 op_sel:[0,0,0]
  v_mfma_f32_16x16x32_bf16 a[20:23], v[80:83], v[132:135], a[20:23]
  v_exp_f32 v56, v56
  v_mfma_f32_16x16x32_bf16 a[52:55], v[84:87], v[132:135], a[52:55]
  v_exp_f32 v57, v57
  v_mfma_f32_16x16x32_bf16 a[24:27], v[80:83], v[136:139], a[24:27]
  v_exp_f32 v58, v58
  v_mfma_f32_16x16x32_bf16 a[56:59], v[84:87], v[136:139], a[56:59]
  v_exp_f32 v59, v59
  v_mfma_f32_16x16x32_bf16 a[28:31], v[80:83], v[140:143], a[28:31]
  v_exp_f32 v60, v60
  v_mfma_f32_16x16x32_bf16 a[60:63], v[84:87], v[140:143], a[60:63]
  s_waitcnt lgkmcnt(5)
  v_exp_f32 v61, v61
  v_mfma_f32_16x16x32_bf16 v[224:227], v[80:83], a[0:3], v[224:227]
  v_exp_f32 v62, v62
  v_mfma_f32_16x16x32_bf16 v[8:11], v[84:87], a[0:3], v[8:11]
  s_waitcnt lgkmcnt(3)
  v_exp_f32 v63, v63
  v_mfma_f32_16x16x32_bf16 v[16:19], a[192:195], a[128:131], v[192:195]
  v_cvt_pk_bf16_f32 v100, v56, v57
  v_cvt_pk_bf16_f32 v101, v58, v59
  v_mfma_f32_16x16x32_bf16 v[24:27], a[192:195], a[144:147], v[192:195]
  v_cvt_pk_bf16_f32 v102, v60, v61
  v_cvt_pk_bf16_f32 v103, v62, v63
  v_mfma_f32_16x16x32_bf16 v[16:19], a[196:199], a[132:135], v[16:19]
  v_cvt_scalef32_pk_bf16_fp4 v149, v185, 2.0 op_sel:[1,0,0]
  v_cvt_scalef32_pk_bf16_fp4 v150, v185, 2.0 op_sel:[0,1,0]
  v_mfma_f32_16x16x32_bf16 v[24:27], a[196:199], a[148:151], v[24:27]
  v_cvt_scalef32_pk_bf16_fp4 v151, v185, 2.0 op_sel:[1,1,0]
  v_cvt_scalef32_pk_bf16_fp4 v152, v186, 2.0 op_sel:[0,0,0]
  v_mfma_f32_16x16x32_bf16 v[16:19], a[200:203], a[136:139], v[16:19]
  v_cvt_scalef32_pk_bf16_fp4 v153, v186, 2.0 op_sel:[1,0,0]
  v_cvt_scalef32_pk_bf16_fp4 v154, v186, 2.0 op_sel:[0,1,0]
  v_mfma_f32_16x16x32_bf16 v[24:27], a[200:203], a[152:155], v[24:27]
  v_cvt_scalef32_pk_bf16_fp4 v155, v186, 2.0 op_sel:[1,1,0]
  v_cvt_scalef32_pk_bf16_fp4 v156, v187, 2.0 op_sel:[0,0,0]
  v_mfma_f32_16x16x32_bf16 v[16:19], a[204:207], a[140:143], v[16:19]
  v_cvt_scalef32_pk_bf16_fp4 v157, v187, 2.0 op_sel:[1,0,0]
  v_cvt_scalef32_pk_bf16_fp4 v158, v187, 2.0 op_sel:[0,1,0]
  v_mfma_f32_16x16x32_bf16 v[24:27], a[204:207], a[156:159], v[24:27]
  v_cvt_scalef32_pk_bf16_fp4 v159, v187, 2.0 op_sel:[1,1,0]
  v_cvt_scalef32_pk_bf16_fp4 v160, v188, 2.0 op_sel:[0,0,0]
  v_mfma_f32_16x16x32_bf16 v[20:23], a[208:211], a[128:131], v[196:199]
  buffer_load_dwordx4 v[184:187], v3, s[64:67], 0 offen sc1
  v_cvt_scalef32_pk_bf16_fp4 v161, v188, 2.0 op_sel:[1,0,0]
  v_mfma_f32_16x16x32_bf16 v[28:31], a[208:211], a[144:147], v[196:199]
  v_cvt_scalef32_pk_bf16_fp4 v162, v188, 2.0 op_sel:[0,1,0]
  v_cvt_scalef32_pk_bf16_fp4 v163, v188, 2.0 op_sel:[1,1,0]
  v_mfma_f32_16x16x32_bf16 v[20:23], a[212:215], a[132:135], v[20:23]
  v_cvt_scalef32_pk_bf16_fp4 v164, v189, 2.0 op_sel:[0,0,0]
  v_cvt_scalef32_pk_bf16_fp4 v165, v189, 2.0 op_sel:[1,0,0]
  v_mfma_f32_16x16x32_bf16 v[28:31], a[212:215], a[148:151], v[28:31]
  v_cvt_scalef32_pk_bf16_fp4 v166, v189, 2.0 op_sel:[0,1,0]
  v_cvt_scalef32_pk_bf16_fp4 v167, v189, 2.0 op_sel:[1,1,0]
  v_mfma_f32_16x16x32_bf16 v[20:23], a[216:219], a[136:139], v[20:23]
  v_cvt_scalef32_pk_bf16_fp4 v168, v190, 2.0 op_sel:[0,0,0]
  v_cvt_scalef32_pk_bf16_fp4 v169, v190, 2.0 op_sel:[1,0,0]
  v_mfma_f32_16x16x32_bf16 v[28:31], a[216:219], a[152:155], v[28:31]
  v_cvt_scalef32_pk_bf16_fp4 v170, v190, 2.0 op_sel:[0,1,0]
  v_cvt_scalef32_pk_bf16_fp4 v171, v190, 2.0 op_sel:[1,1,0]
  v_mfma_f32_16x16x32_bf16 v[20:23], a[220:223], a[140:143], v[20:23]
  v_cvt_scalef32_pk_bf16_fp4 v172, v191, 2.0 op_sel:[0,0,0]
  v_cvt_scalef32_pk_bf16_fp4 v173, v191, 2.0 op_sel:[1,0,0]
  v_mfma_f32_16x16x32_bf16 v[28:31], a[220:223], a[156:159], v[28:31]
  v_cvt_scalef32_pk_bf16_fp4 v174, v191, 2.0 op_sel:[0,1,0]
  v_cvt_scalef32_pk_bf16_fp4 v175, v191, 2.0 op_sel:[1,1,0]
  v_mfma_f32_16x16x32_bf16 v[208:211], v[88:91], v[112:115], v[208:211]
  v_exp_f32 v64, v64
  v_mfma_f32_16x16x32_bf16 a[96:99], v[92:95], v[112:115], a[96:99]
  v_exp_f32 v65, v65
  v_mfma_f32_16x16x32_bf16 v[212:215], v[88:91], v[116:119], v[212:215]
  buffer_load_dwordx4 v[188:191], v232, s[64:67], 0 offen sc1
  v_cvt_pk_bf16_f32 v104, v64, v65
  v_mfma_f32_16x16x32_bf16 a[100:103], v[92:95], v[116:119], a[100:103]
  s_xor_b32 s64, s43, 0x1c000
  v_exp_f32 v66, v66
  v_mfma_f32_16x16x32_bf16 v[216:219], v[88:91], v[120:123], v[216:219]
  v_exp_f32 v67, v67
  v_mfma_f32_16x16x32_bf16 a[104:107], v[92:95], v[120:123], a[104:107]
  v_exp_f32 v68, v68
  v_mfma_f32_16x16x32_bf16 v[220:223], v[88:91], v[124:127], v[220:223]
  v_exp_f32 v69, v69
  v_mfma_f32_16x16x32_bf16 a[108:111], v[92:95], v[124:127], a[108:111]
  v_exp_f32 v70, v70
  v_mfma_f32_16x16x32_bf16 a[80:83], v[88:91], v[128:131], a[80:83]
  v_exp_f32 v71, v71
  v_mfma_f32_16x16x32_bf16 a[112:115], v[92:95], v[128:131], a[112:115]
  v_cvt_pk_bf16_f32 v105, v66, v67
  v_cvt_pk_bf16_f32 v106, v68, v69
  v_mfma_f32_16x16x32_bf16 a[84:87], v[88:91], v[132:135], a[84:87]
  v_exp_f32 v72, v72
  v_mfma_f32_16x16x32_bf16 a[116:119], v[92:95], v[132:135], a[116:119]
  v_exp_f32 v73, v73
  v_mfma_f32_16x16x32_bf16 a[88:91], v[88:91], v[136:139], a[88:91]
  v_cvt_pk_bf16_f32 v107, v70, v71
  v_cvt_pk_bf16_f32 v108, v72, v73
  v_mfma_f32_16x16x32_bf16 a[120:123], v[92:95], v[136:139], a[120:123]
  v_exp_f32 v74, v74
  v_mfma_f32_16x16x32_bf16 a[92:95], v[88:91], v[140:143], a[92:95]
  v_exp_f32 v75, v75
  v_mfma_f32_16x16x32_bf16 a[124:127], v[92:95], v[140:143], a[124:127]
  v_exp_f32 v76, v76
  v_mfma_f32_16x16x32_bf16 v[228:231], v[88:91], a[0:3], v[228:231]
  v_exp_f32 v77, v77
  v_mfma_f32_16x16x32_bf16 v[236:239], v[92:95], a[0:3], v[236:239]
  ds_read_b128 a[0:3], v5 offset:1088
  v_cvt_pk_bf16_f32 v109, v74, v75
  v_mfma_f32_16x16x32_bf16 v[32:35], a[192:195], a[160:163], v[192:195]
  v_exp_f32 v78, v78
  v_mfma_f32_16x16x32_bf16 v[40:43], a[192:195], a[176:179], v[192:195]
  buffer_load_dwordx4 a[192:195], v1, s[60:63], 0 offen offset:0 sc1
  ds_read_b128 v[192:195], v4 offset:768
  v_mfma_f32_16x16x32_bf16 v[32:35], a[196:199], a[164:167], v[32:35]
  v_exp_f32 v79, v79
  v_mfma_f32_16x16x32_bf16 v[40:43], a[196:199], a[180:183], v[40:43]
  v_cvt_pk_bf16_f32 v110, v76, v77
  v_cvt_pk_bf16_f32 v111, v78, v79
  v_mfma_f32_16x16x32_bf16 v[32:35], a[200:203], a[168:171], v[32:35]
  v_exp_f32 v16, v16
  v_mfma_f32_16x16x32_bf16 v[40:43], a[200:203], a[184:187], v[40:43]
  buffer_load_dwordx4 a[196:199], v1, s[60:63], 0 offen offset:1024 sc1
  v_mfma_f32_16x16x32_bf16 v[32:35], a[204:207], a[172:175], v[32:35]
  v_exp_f32 v17, v17
  v_mfma_f32_16x16x32_bf16 v[40:43], a[204:207], a[188:191], v[40:43]
  v_exp_f32 v18, v18
  v_mfma_f32_16x16x32_bf16 v[36:39], a[208:211], a[160:163], v[196:199]
  v_exp_f32 v19, v19
  v_mfma_f32_16x16x32_bf16 v[44:47], a[208:211], a[176:179], v[196:199]
  buffer_load_dwordx4 a[208:211], v2, s[60:63], 0 offen offset:0 sc1
  ds_read_b128 v[196:199], v4 offset:832
  v_mfma_f32_16x16x32_bf16 v[36:39], a[212:215], a[164:167], v[36:39]
  v_exp_f32 v20, v20
  v_mfma_f32_16x16x32_bf16 v[44:47], a[212:215], a[180:183], v[44:47]
  v_exp_f32 v21, v21
  v_mfma_f32_16x16x32_bf16 v[36:39], a[216:219], a[168:171], v[36:39]
  v_exp_f32 v22, v22
  v_mfma_f32_16x16x32_bf16 v[44:47], a[216:219], a[184:187], v[44:47]
  buffer_load_dwordx4 a[212:215], v2, s[60:63], 0 offen offset:1024 sc1
  v_cvt_pk_bf16_f32 v80, v16, v17
  v_mfma_f32_16x16x32_bf16 v[36:39], a[220:223], a[172:175], v[36:39]
  s_waitcnt vmcnt(14)
  v_exp_f32 v23, v23
  v_mfma_f32_16x16x32_bf16 v[44:47], a[220:223], a[188:191], v[44:47]
  v_cvt_pk_bf16_f32 v81, v18, v19
  v_cvt_pk_bf16_f32 v82, v20, v21
  v_mfma_f32_16x16x32_bf16 v[240:243], v[96:99], v[144:147], v[240:243]
  v_cvt_pk_bf16_f32 v83, v22, v23
  v_cvt_scalef32_pk_bf16_fp4 v112, v176, 2.0 op_sel:[0,0,0]
  v_mfma_f32_16x16x32_bf16 a[32:35], v[100:103], v[144:147], a[32:35]
  buffer_load_dwordx4 a[200:203], v1, s[60:63], 0 offen offset:2048 sc1
  v_cvt_scalef32_pk_bf16_fp4 v113, v176, 2.0 op_sel:[1,0,0]
  v_mfma_f32_16x16x32_bf16 v[244:247], v[96:99], v[148:151], v[244:247]
  v_cvt_scalef32_pk_bf16_fp4 v114, v176, 2.0 op_sel:[0,1,0]
  v_cvt_scalef32_pk_bf16_fp4 v115, v176, 2.0 op_sel:[1,1,0]
  v_mfma_f32_16x16x32_bf16 a[36:39], v[100:103], v[148:151], a[36:39]
  v_exp_f32 v24, v24
  v_mfma_f32_16x16x32_bf16 v[248:251], v[96:99], v[152:155], v[248:251]
  v_exp_f32 v25, v25
  v_mfma_f32_16x16x32_bf16 a[40:43], v[100:103], v[152:155], a[40:43]
  buffer_load_dwordx4 a[216:219], v2, s[60:63], 0 offen offset:2048 sc1
  v_cvt_pk_bf16_f32 v84, v24, v25
  v_mfma_f32_16x16x32_bf16 v[252:255], v[96:99], v[156:159], v[252:255]
  v_exp_f32 v26, v26
  v_mfma_f32_16x16x32_bf16 a[44:47], v[100:103], v[156:159], a[44:47]
  v_exp_f32 v27, v27
  v_mfma_f32_16x16x32_bf16 a[16:19], v[96:99], v[160:163], a[16:19]
  v_exp_f32 v28, v28
  v_mfma_f32_16x16x32_bf16 a[48:51], v[100:103], v[160:163], a[48:51]
  buffer_load_dwordx4 a[204:207], v1, s[60:63], 0 offen offset:3072 sc1
  v_cvt_pk_bf16_f32 v85, v26, v27
  v_mfma_f32_16x16x32_bf16 a[20:23], v[96:99], v[164:167], a[20:23]
  v_exp_f32 v29, v29
  v_mfma_f32_16x16x32_bf16 a[52:55], v[100:103], v[164:167], a[52:55]
  v_exp_f32 v30, v30
  v_mfma_f32_16x16x32_bf16 a[24:27], v[96:99], v[168:171], a[24:27]
  v_exp_f32 v31, v31
  v_mfma_f32_16x16x32_bf16 a[56:59], v[100:103], v[168:171], a[56:59]
  buffer_load_dwordx4 a[220:223], v2, s[60:63], 0 offen offset:3072 sc1
  v_cvt_pk_bf16_f32 v86, v28, v29
  v_mfma_f32_16x16x32_bf16 a[28:31], v[96:99], v[172:175], a[28:31]
  v_cvt_pk_bf16_f32 v87, v30, v31
  v_cvt_scalef32_pk_bf16_fp4 v116, v177, 2.0 op_sel:[0,0,0]
  v_mfma_f32_16x16x32_bf16 a[60:63], v[100:103], v[172:175], a[60:63]
  s_waitcnt lgkmcnt(5)
  v_cvt_scalef32_pk_bf16_fp4 v117, v177, 2.0 op_sel:[1,0,0]
  v_cvt_scalef32_pk_bf16_fp4 v118, v177, 2.0 op_sel:[0,1,0]
  v_mfma_f32_16x16x32_bf16 v[224:227], v[96:99], a[4:7], v[224:227]
  v_cvt_scalef32_pk_bf16_fp4 v119, v177, 2.0 op_sel:[1,1,0]
  v_cvt_scalef32_pk_bf16_fp4 v120, v178, 2.0 op_sel:[0,0,0]
  v_mfma_f32_16x16x32_bf16 v[8:11], v[100:103], a[4:7], v[8:11]
  s_waitcnt vmcnt(14) lgkmcnt(3)
  v_cvt_scalef32_pk_bf16_fp4 v121, v178, 2.0 op_sel:[1,0,0]
  v_cvt_scalef32_pk_bf16_fp4 v122, v178, 2.0 op_sel:[0,1,0]
  v_mfma_f32_16x16x32_bf16 v[48:51], a[224:227], a[128:131], v[200:203]
  v_cvt_scalef32_pk_bf16_fp4 v123, v178, 2.0 op_sel:[1,1,0]
  v_cvt_scalef32_pk_bf16_fp4 v124, v179, 2.0 op_sel:[0,0,0]
  v_mfma_f32_16x16x32_bf16 v[56:59], a[224:227], a[144:147], v[200:203]
  v_cvt_scalef32_pk_bf16_fp4 v125, v179, 2.0 op_sel:[1,0,0]
  v_cvt_scalef32_pk_bf16_fp4 v126, v179, 2.0 op_sel:[0,1,0]
  v_mfma_f32_16x16x32_bf16 v[48:51], a[228:231], a[132:135], v[48:51]
  v_cvt_scalef32_pk_bf16_fp4 v127, v179, 2.0 op_sel:[1,1,0]
  v_cvt_scalef32_pk_bf16_fp4 v128, v180, 2.0 op_sel:[0,0,0]
  v_mfma_f32_16x16x32_bf16 v[56:59], a[228:231], a[148:151], v[56:59]
  buffer_load_dwordx4 v[176:179], v3, s[60:63], 0 offen sc1
  v_cvt_scalef32_pk_bf16_fp4 v129, v180, 2.0 op_sel:[1,0,0]
  v_mfma_f32_16x16x32_bf16 v[48:51], a[232:235], a[136:139], v[48:51]
  v_cvt_scalef32_pk_bf16_fp4 v130, v180, 2.0 op_sel:[0,1,0]
  v_cvt_scalef32_pk_bf16_fp4 v131, v180, 2.0 op_sel:[1,1,0]
  v_mfma_f32_16x16x32_bf16 v[56:59], a[232:235], a[152:155], v[56:59]
  v_cvt_scalef32_pk_bf16_fp4 v132, v181, 2.0 op_sel:[0,0,0]
  v_cvt_scalef32_pk_bf16_fp4 v133, v181, 2.0 op_sel:[1,0,0]
  v_mfma_f32_16x16x32_bf16 v[48:51], a[236:239], a[140:143], v[48:51]
  v_cvt_scalef32_pk_bf16_fp4 v134, v181, 2.0 op_sel:[0,1,0]
  v_cvt_scalef32_pk_bf16_fp4 v135, v181, 2.0 op_sel:[1,1,0]
  v_mfma_f32_16x16x32_bf16 v[56:59], a[236:239], a[156:159], v[56:59]
  s_waitcnt vmcnt(11)
  v_cvt_scalef32_pk_bf16_fp4 v136, v182, 2.0 op_sel:[0,0,0]
  v_cvt_scalef32_pk_bf16_fp4 v137, v182, 2.0 op_sel:[1,0,0]
  v_mfma_f32_16x16x32_bf16 v[52:55], a[240:243], a[128:131], v[204:207]
  v_cvt_scalef32_pk_bf16_fp4 v138, v182, 2.0 op_sel:[0,1,0]
  v_cvt_scalef32_pk_bf16_fp4 v139, v182, 2.0 op_sel:[1,1,0]
  v_mfma_f32_16x16x32_bf16 v[60:63], a[240:243], a[144:147], v[204:207]
  v_cvt_scalef32_pk_bf16_fp4 v140, v183, 2.0 op_sel:[0,0,0]
  v_cvt_scalef32_pk_bf16_fp4 v141, v183, 2.0 op_sel:[1,0,0]
  v_mfma_f32_16x16x32_bf16 v[52:55], a[244:247], a[132:135], v[52:55]
  v_cvt_scalef32_pk_bf16_fp4 v142, v183, 2.0 op_sel:[0,1,0]
  v_cvt_scalef32_pk_bf16_fp4 v143, v183, 2.0 op_sel:[1,1,0]
  v_mfma_f32_16x16x32_bf16 v[60:63], a[244:247], a[148:151], v[60:63]
  v_exp_f32 v32, v32
  v_mfma_f32_16x16x32_bf16 v[52:55], a[248:251], a[136:139], v[52:55]
  v_exp_f32 v33, v33
  v_mfma_f32_16x16x32_bf16 v[60:63], a[248:251], a[152:155], v[60:63]
  buffer_load_dwordx4 v[180:183], v232, s[60:63], 0 offen sc1
  v_cvt_pk_bf16_f32 v88, v32, v33
  v_mfma_f32_16x16x32_bf16 v[52:55], a[252:255], a[140:143], v[52:55]
  v_exp_f32 v34, v34
  v_mfma_f32_16x16x32_bf16 v[60:63], a[252:255], a[156:159], v[60:63]
  v_exp_f32 v35, v35
  v_mfma_f32_16x16x32_bf16 v[208:211], v[104:107], v[144:147], v[208:211]
  v_exp_f32 v36, v36
  v_mfma_f32_16x16x32_bf16 a[96:99], v[108:111], v[144:147], a[96:99]
  v_exp_f32 v37, v37
  v_mfma_f32_16x16x32_bf16 v[212:215], v[104:107], v[148:151], v[212:215]
  v_exp_f32 v38, v38
  v_mfma_f32_16x16x32_bf16 a[100:103], v[108:111], v[148:151], a[100:103]
  v_exp_f32 v39, v39
  v_mfma_f32_16x16x32_bf16 v[216:219], v[104:107], v[152:155], v[216:219]
  v_cvt_pk_bf16_f32 v89, v34, v35
  v_cvt_pk_bf16_f32 v90, v36, v37
  v_mfma_f32_16x16x32_bf16 a[104:107], v[108:111], v[152:155], a[104:107]
  v_exp_f32 v40, v40
  v_mfma_f32_16x16x32_bf16 v[220:223], v[104:107], v[156:159], v[220:223]
  v_exp_f32 v41, v41
  v_mfma_f32_16x16x32_bf16 a[108:111], v[108:111], v[156:159], a[108:111]
  v_cvt_pk_bf16_f32 v91, v38, v39
  v_cvt_pk_bf16_f32 v92, v40, v41
  v_mfma_f32_16x16x32_bf16 a[80:83], v[104:107], v[160:163], a[80:83]
  s_waitcnt vmcnt(10)
  v_exp_f32 v42, v42
  v_mfma_f32_16x16x32_bf16 a[112:115], v[108:111], v[160:163], a[112:115]
  v_exp_f32 v43, v43
  v_mfma_f32_16x16x32_bf16 a[84:87], v[104:107], v[164:167], a[84:87]
  v_exp_f32 v44, v44
  v_mfma_f32_16x16x32_bf16 a[116:119], v[108:111], v[164:167], a[116:119]
  v_exp_f32 v45, v45
  v_mfma_f32_16x16x32_bf16 a[88:91], v[104:107], v[168:171], a[88:91]
  v_exp_f32 v46, v46
  v_mfma_f32_16x16x32_bf16 a[120:123], v[108:111], v[168:171], a[120:123]
  v_exp_f32 v47, v47
  v_mfma_f32_16x16x32_bf16 a[92:95], v[104:107], v[172:175], a[92:95]
  v_cvt_pk_bf16_f32 v93, v42, v43
  v_cvt_pk_bf16_f32 v94, v44, v45
  v_mfma_f32_16x16x32_bf16 a[124:127], v[108:111], v[172:175], a[124:127]
  v_cvt_pk_bf16_f32 v95, v46, v47
  v_cvt_scalef32_pk_bf16_fp4 v144, v184, 2.0 op_sel:[0,0,0]
  v_mfma_f32_16x16x32_bf16 v[228:231], v[104:107], a[4:7], v[228:231]
  v_cvt_scalef32_pk_bf16_fp4 v145, v184, 2.0 op_sel:[1,0,0]
  v_cvt_scalef32_pk_bf16_fp4 v146, v184, 2.0 op_sel:[0,1,0]
  v_mfma_f32_16x16x32_bf16 v[236:239], v[108:111], a[4:7], v[236:239]
  ds_read_b128 a[4:7], v5 offset:1360
  v_cvt_scalef32_pk_bf16_fp4 v147, v184, 2.0 op_sel:[1,1,0]
  v_mfma_f32_16x16x32_bf16 v[64:67], a[224:227], a[160:163], v[200:203]
  v_cvt_scalef32_pk_bf16_fp4 v148, v185, 2.0 op_sel:[0,0,0]
  v_cvt_scalef32_pk_bf16_fp4 v149, v185, 2.0 op_sel:[1,0,0]
  v_mfma_f32_16x16x32_bf16 v[72:75], a[224:227], a[176:179], v[200:203]
  buffer_load_dwordx4 a[224:227], v1, s[64:67], 0 offen offset:0 sc1
  ds_read_b128 v[200:203], v4 offset:896
  v_mfma_f32_16x16x32_bf16 v[64:67], a[228:231], a[164:167], v[64:67]
  v_cvt_scalef32_pk_bf16_fp4 v150, v185, 2.0 op_sel:[0,1,0]
  v_cvt_scalef32_pk_bf16_fp4 v151, v185, 2.0 op_sel:[1,1,0]
  v_mfma_f32_16x16x32_bf16 v[72:75], a[228:231], a[180:183], v[72:75]
  v_cvt_scalef32_pk_bf16_fp4 v152, v186, 2.0 op_sel:[0,0,0]
  v_cvt_scalef32_pk_bf16_fp4 v153, v186, 2.0 op_sel:[1,0,0]
  v_mfma_f32_16x16x32_bf16 v[64:67], a[232:235], a[168:171], v[64:67]
  v_cvt_scalef32_pk_bf16_fp4 v154, v186, 2.0 op_sel:[0,1,0]
  v_cvt_scalef32_pk_bf16_fp4 v155, v186, 2.0 op_sel:[1,1,0]
  v_mfma_f32_16x16x32_bf16 v[72:75], a[232:235], a[184:187], v[72:75]
  buffer_load_dwordx4 a[228:231], v1, s[64:67], 0 offen offset:1024 sc1
  v_cvt_scalef32_pk_bf16_fp4 v156, v187, 2.0 op_sel:[0,0,0]
  v_mfma_f32_16x16x32_bf16 v[64:67], a[236:239], a[172:175], v[64:67]
  v_cvt_scalef32_pk_bf16_fp4 v157, v187, 2.0 op_sel:[1,0,0]
  v_cvt_scalef32_pk_bf16_fp4 v158, v187, 2.0 op_sel:[0,1,0]
  v_mfma_f32_16x16x32_bf16 v[72:75], a[236:239], a[188:191], v[72:75]
  v_cvt_scalef32_pk_bf16_fp4 v159, v187, 2.0 op_sel:[1,1,0]
  v_cvt_scalef32_pk_bf16_fp4 v160, v188, 2.0 op_sel:[0,0,0]
  v_mfma_f32_16x16x32_bf16 v[68:71], a[240:243], a[160:163], v[204:207]
  v_exp_f32 v48, v48
  v_mfma_f32_16x16x32_bf16 v[76:79], a[240:243], a[176:179], v[204:207]
  buffer_load_dwordx4 a[240:243], v2, s[64:67], 0 offen offset:0 sc1
  ds_read_b128 v[204:207], v4 offset:960
  v_mfma_f32_16x16x32_bf16 v[68:71], a[244:247], a[164:167], v[68:71]
  v_exp_f32 v49, v49
  v_mfma_f32_16x16x32_bf16 v[76:79], a[244:247], a[180:183], v[76:79]
  v_exp_f32 v50, v50
  v_mfma_f32_16x16x32_bf16 v[68:71], a[248:251], a[168:171], v[68:71]
  v_exp_f32 v51, v51
  v_mfma_f32_16x16x32_bf16 v[76:79], a[248:251], a[184:187], v[76:79]
  buffer_load_dwordx4 a[244:247], v2, s[64:67], 0 offen offset:1024 sc1
  v_cvt_pk_bf16_f32 v96, v48, v49
  v_mfma_f32_16x16x32_bf16 v[68:71], a[252:255], a[172:175], v[68:71]
  v_exp_f32 v52, v52
  v_mfma_f32_16x16x32_bf16 v[76:79], a[252:255], a[188:191], v[76:79]
  v_exp_f32 v53, v53
  v_mfma_f32_16x16x32_bf16 v[240:243], v[80:83], v[112:115], v[240:243]
  v_exp_f32 v54, v54
  v_mfma_f32_16x16x32_bf16 a[32:35], v[84:87], v[112:115], a[32:35]
  buffer_load_dwordx4 a[232:235], v1, s[64:67], 0 offen offset:2048 sc1
  v_cvt_pk_bf16_f32 v97, v50, v51
  v_mfma_f32_16x16x32_bf16 v[244:247], v[80:83], v[116:119], v[244:247]
  v_exp_f32 v55, v55
  v_mfma_f32_16x16x32_bf16 a[36:39], v[84:87], v[116:119], a[36:39]
  v_cvt_pk_bf16_f32 v98, v52, v53
  v_cvt_pk_bf16_f32 v99, v54, v55
  v_mfma_f32_16x16x32_bf16 v[248:251], v[80:83], v[120:123], v[248:251]
  v_exp_f32 v56, v56
  v_mfma_f32_16x16x32_bf16 a[40:43], v[84:87], v[120:123], a[40:43]
  buffer_load_dwordx4 a[248:251], v2, s[64:67], 0 offen offset:2048 sc1
  v_cvt_scalef32_pk_bf16_fp4 v161, v188, 2.0 op_sel:[1,0,0]
  v_mfma_f32_16x16x32_bf16 v[252:255], v[80:83], v[124:127], v[252:255]
  v_exp_f32 v57, v57
  v_mfma_f32_16x16x32_bf16 a[44:47], v[84:87], v[124:127], a[44:47]
  v_exp_f32 v58, v58
  v_mfma_f32_16x16x32_bf16 a[16:19], v[80:83], v[128:131], a[16:19]
  v_exp_f32 v59, v59
  v_mfma_f32_16x16x32_bf16 a[48:51], v[84:87], v[128:131], a[48:51]
  buffer_load_dwordx4 a[252:255], v2, s[64:67], 0 offen offset:3072 sc1
  v_cvt_pk_bf16_f32 v100, v56, v57
  v_mfma_f32_16x16x32_bf16 a[20:23], v[80:83], v[132:135], a[20:23]
  v_exp_f32 v60, v60
  v_mfma_f32_16x16x32_bf16 a[52:55], v[84:87], v[132:135], a[52:55]
  v_exp_f32 v61, v61
  v_mfma_f32_16x16x32_bf16 a[24:27], v[80:83], v[136:139], a[24:27]
  v_exp_f32 v62, v62
  v_mfma_f32_16x16x32_bf16 a[56:59], v[84:87], v[136:139], a[56:59]
  buffer_load_dwordx4 a[236:239], v1, s[64:67], 0 offen offset:3072 sc1
  v_cvt_pk_bf16_f32 v101, v58, v59
  v_mfma_f32_16x16x32_bf16 a[28:31], v[80:83], v[140:143], a[28:31]
  v_exp_f32 v63, v63
  v_mfma_f32_16x16x32_bf16 a[60:63], v[84:87], v[140:143], a[60:63]
  s_waitcnt lgkmcnt(5)
  v_cvt_pk_bf16_f32 v102, v60, v61
  v_cvt_pk_bf16_f32 v103, v62, v63
  v_mfma_f32_16x16x32_bf16 v[224:227], v[80:83], a[0:3], v[224:227]
  v_cvt_scalef32_pk_bf16_fp4 v162, v188, 2.0 op_sel:[0,1,0]
  v_cvt_scalef32_pk_bf16_fp4 v163, v188, 2.0 op_sel:[1,1,0]
  v_mfma_f32_16x16x32_bf16 v[8:11], v[84:87], a[0:3], v[8:11]
  s_waitcnt vmcnt(11) lgkmcnt(3)
  v_cvt_scalef32_pk_bf16_fp4 v164, v189, 2.0 op_sel:[0,0,0]
  v_cvt_scalef32_pk_bf16_fp4 v165, v189, 2.0 op_sel:[1,0,0]
  v_mfma_f32_16x16x32_bf16 v[24:27], a[192:195], a[144:147], v[192:195]
  s_waitcnt vmcnt(10)
  v_cvt_scalef32_pk_bf16_fp4 v166, v189, 2.0 op_sel:[0,1,0]
  v_cvt_scalef32_pk_bf16_fp4 v167, v189, 2.0 op_sel:[1,1,0]
  v_mfma_f32_16x16x32_bf16 v[28:31], a[208:211], a[144:147], v[196:199]
  buffer_load_dwordx4 v[184:187], v3, s[64:67], 0 offen sc1
  v_cvt_scalef32_pk_bf16_fp4 v168, v190, 2.0 op_sel:[0,0,0]
  v_mfma_f32_16x16x32_bf16 v[24:27], a[196:199], a[148:151], v[24:27]
  v_cvt_scalef32_pk_bf16_fp4 v169, v190, 2.0 op_sel:[1,0,0]
  v_cvt_scalef32_pk_bf16_fp4 v170, v190, 2.0 op_sel:[0,1,0]
  v_mfma_f32_16x16x32_bf16 v[28:31], a[212:215], a[148:151], v[28:31]
  v_cvt_scalef32_pk_bf16_fp4 v171, v190, 2.0 op_sel:[1,1,0]
  v_cvt_scalef32_pk_bf16_fp4 v172, v191, 2.0 op_sel:[0,0,0]
  v_mfma_f32_16x16x32_bf16 v[24:27], a[200:203], a[152:155], v[24:27]
  v_cvt_scalef32_pk_bf16_fp4 v173, v191, 2.0 op_sel:[1,0,0]
  v_cvt_scalef32_pk_bf16_fp4 v174, v191, 2.0 op_sel:[0,1,0]
  v_mfma_f32_16x16x32_bf16 v[28:31], a[216:219], a[152:155], v[28:31]
  v_exp_f32 v64, v64
  v_mfma_f32_16x16x32_bf16 v[24:27], a[204:207], a[156:159], v[24:27]
  buffer_store_dwordx4 a[64:67], v1, s[72:75], 0 offen offset:0 sc1
  v_mfma_f32_16x16x32_bf16 v[28:31], a[220:223], a[156:159], v[28:31]
  v_exp_f32 v65, v65
  v_mfma_f32_16x16x32_bf16 v[208:211], v[88:91], v[112:115], v[208:211]
  v_cvt_scalef32_pk_bf16_fp4 v175, v191, 2.0 op_sel:[1,1,0]
  v_cvt_pk_bf16_f32 v104, v64, v65
  v_mfma_f32_16x16x32_bf16 a[96:99], v[92:95], v[112:115], a[96:99]
  v_exp_f32 v66, v66
  v_mfma_f32_16x16x32_bf16 v[212:215], v[88:91], v[116:119], v[212:215]
  buffer_store_dwordx4 a[64:67], v1, s[72:75], 0 offen offset:1024 sc1
  v_mfma_f32_16x16x32_bf16 a[100:103], v[92:95], v[116:119], a[100:103]
  v_exp_f32 v67, v67
  v_mfma_f32_16x16x32_bf16 v[216:219], v[88:91], v[120:123], v[216:219]
  v_exp_f32 v68, v68
  v_mfma_f32_16x16x32_bf16 a[104:107], v[92:95], v[120:123], a[104:107]
  v_exp_f32 v69, v69
  v_mfma_f32_16x16x32_bf16 v[220:223], v[88:91], v[124:127], v[220:223]
  buffer_store_dwordx4 a[64:67], v15, s[72:75], 0 offen offset:2048 sc1
  v_mfma_f32_16x16x32_bf16 a[108:111], v[92:95], v[124:127], a[108:111]
  v_exp_f32 v70, v70
  v_mfma_f32_16x16x32_bf16 a[80:83], v[88:91], v[128:131], a[80:83]
  v_exp_f32 v71, v71
  v_mfma_f32_16x16x32_bf16 a[112:115], v[92:95], v[128:131], a[112:115]
  v_cvt_pk_bf16_f32 v105, v66, v67
  v_cvt_pk_bf16_f32 v106, v68, v69
  v_mfma_f32_16x16x32_bf16 a[84:87], v[88:91], v[132:135], a[84:87]
  buffer_store_dwordx4 a[68:71], v1, s[80:83], 0 offen sc1
  v_mfma_f32_16x16x32_bf16 a[116:119], v[92:95], v[132:135], a[116:119]
  v_exp_f32 v72, v72
  v_mfma_f32_16x16x32_bf16 a[88:91], v[88:91], v[136:139], a[88:91]
  v_exp_f32 v73, v73
  v_mfma_f32_16x16x32_bf16 a[120:123], v[92:95], v[136:139], a[120:123]
  v_cvt_pk_bf16_f32 v107, v70, v71
  v_cvt_pk_bf16_f32 v108, v72, v73
  v_mfma_f32_16x16x32_bf16 a[92:95], v[88:91], v[140:143], a[92:95]
  v_exp_f32 v74, v74
  v_mfma_f32_16x16x32_bf16 a[124:127], v[92:95], v[140:143], a[124:127]
  v_exp_f32 v75, v75
  v_mfma_f32_16x16x32_bf16 v[228:231], v[88:91], a[0:3], v[228:231]
  buffer_load_dwordx4 v[188:191], v232, s[64:67], 0 offen sc1
  v_cvt_pk_bf16_f32 v109, v74, v75
  v_mfma_f32_16x16x32_bf16 v[236:239], v[92:95], a[0:3], v[236:239]
  v_exp_f32 v76, v76
  v_mfma_f32_16x16x32_bf16 v[16:19], a[192:195], a[128:131], v[192:195]
  v_exp_f32 v77, v77
  v_mfma_f32_16x16x32_bf16 v[20:23], a[208:211], a[128:131], v[196:199]
  ds_read_b128 a[0:3], v5 offset:1632
  v_cvt_pk_bf16_f32 v110, v76, v77
  v_mfma_f32_16x16x32_bf16 v[16:19], a[196:199], a[132:135], v[16:19]
  v_exp_f32 v78, v78
  v_mfma_f32_16x16x32_bf16 v[20:23], a[212:215], a[132:135], v[20:23]
  v_exp_f32 v79, v79
  v_mfma_f32_16x16x32_bf16 v[16:19], a[200:203], a[136:139], v[16:19]
  v_exp_f32 v24, v24
  v_mfma_f32_16x16x32_bf16 v[20:23], a[216:219], a[136:139], v[20:23]
  v_exp_f32 v25, v25
  v_mfma_f32_16x16x32_bf16 v[16:19], a[204:207], a[140:143], v[16:19]
  v_cvt_pk_bf16_f32 v111, v78, v79
  v_cvt_pk_bf16_f32 v84, v24, v25
  v_mfma_f32_16x16x32_bf16 v[20:23], a[220:223], a[140:143], v[20:23]
  s_waitcnt vmcnt(14)
  v_exp_f32 v26, v26
  v_mfma_f32_16x16x32_bf16 v[240:243], v[96:99], v[144:147], v[240:243]
  v_exp_f32 v27, v27
  v_mfma_f32_16x16x32_bf16 a[32:35], v[100:103], v[144:147], a[32:35]
  v_exp_f32 v28, v28
  v_mfma_f32_16x16x32_bf16 v[244:247], v[96:99], v[148:151], v[244:247]
  v_exp_f32 v29, v29
  v_mfma_f32_16x16x32_bf16 a[36:39], v[100:103], v[148:151], a[36:39]
  v_exp_f32 v30, v30
  v_mfma_f32_16x16x32_bf16 v[248:251], v[96:99], v[152:155], v[248:251]
  v_exp_f32 v31, v31
  v_mfma_f32_16x16x32_bf16 a[40:43], v[100:103], v[152:155], a[40:43]
  v_cvt_pk_bf16_f32 v85, v26, v27
  v_cvt_pk_bf16_f32 v86, v28, v29
  v_mfma_f32_16x16x32_bf16 v[252:255], v[96:99], v[156:159], v[252:255]
  v_cvt_pk_bf16_f32 v87, v30, v31
  v_cvt_scalef32_pk_bf16_fp4 v112, v176, 2.0 op_sel:[0,0,0]
  v_mfma_f32_16x16x32_bf16 a[44:47], v[100:103], v[156:159], a[44:47]
  v_cvt_scalef32_pk_bf16_fp4 v113, v176, 2.0 op_sel:[1,0,0]
  v_cvt_scalef32_pk_bf16_fp4 v114, v176, 2.0 op_sel:[0,1,0]
  v_mfma_f32_16x16x32_bf16 a[16:19], v[96:99], v[160:163], a[16:19]
  v_cvt_scalef32_pk_bf16_fp4 v115, v176, 2.0 op_sel:[1,1,0]
  v_cvt_scalef32_pk_bf16_fp4 v116, v177, 2.0 op_sel:[0,0,0]
  v_mfma_f32_16x16x32_bf16 a[48:51], v[100:103], v[160:163], a[48:51]
  v_cvt_scalef32_pk_bf16_fp4 v117, v177, 2.0 op_sel:[1,0,0]
  v_cvt_scalef32_pk_bf16_fp4 v118, v177, 2.0 op_sel:[0,1,0]
  v_mfma_f32_16x16x32_bf16 a[20:23], v[96:99], v[164:167], a[20:23]
  v_cvt_scalef32_pk_bf16_fp4 v119, v177, 2.0 op_sel:[1,1,0]
  v_cvt_scalef32_pk_bf16_fp4 v120, v178, 2.0 op_sel:[0,0,0]
  v_mfma_f32_16x16x32_bf16 a[52:55], v[100:103], v[164:167], a[52:55]
  v_cvt_scalef32_pk_bf16_fp4 v121, v178, 2.0 op_sel:[1,0,0]
  v_cvt_scalef32_pk_bf16_fp4 v122, v178, 2.0 op_sel:[0,1,0]
  v_mfma_f32_16x16x32_bf16 a[24:27], v[96:99], v[168:171], a[24:27]
  v_cvt_scalef32_pk_bf16_fp4 v123, v178, 2.0 op_sel:[1,1,0]
  v_cvt_scalef32_pk_bf16_fp4 v124, v179, 2.0 op_sel:[0,0,0]
  v_mfma_f32_16x16x32_bf16 a[56:59], v[100:103], v[168:171], a[56:59]
  v_cvt_scalef32_pk_bf16_fp4 v125, v179, 2.0 op_sel:[1,0,0]
  v_cvt_scalef32_pk_bf16_fp4 v126, v179, 2.0 op_sel:[0,1,0]
  v_mfma_f32_16x16x32_bf16 a[28:31], v[96:99], v[172:175], a[28:31]
  v_cvt_scalef32_pk_bf16_fp4 v127, v179, 2.0 op_sel:[1,1,0]
  v_cvt_scalef32_pk_bf16_fp4 v132, v181, 2.0 op_sel:[0,0,0]
  v_mfma_f32_16x16x32_bf16 a[60:63], v[100:103], v[172:175], a[60:63]
  s_waitcnt lgkmcnt(3)
  v_cvt_scalef32_pk_bf16_fp4 v133, v181, 2.0 op_sel:[1,0,0]
  v_cvt_scalef32_pk_bf16_fp4 v134, v181, 2.0 op_sel:[0,1,0]
  v_mfma_f32_16x16x32_bf16 v[224:227], v[96:99], a[4:7], v[224:227]
  v_cvt_scalef32_pk_bf16_fp4 v135, v181, 2.0 op_sel:[1,1,0]
  v_cvt_scalef32_pk_bf16_fp4 v128, v180, 2.0 op_sel:[0,0,0]
  v_mfma_f32_16x16x32_bf16 v[8:11], v[100:103], a[4:7], v[8:11]
  s_waitcnt vmcnt(6) lgkmcnt(1)
  v_cvt_scalef32_pk_bf16_fp4 v129, v180, 2.0 op_sel:[1,0,0]
  v_cvt_scalef32_pk_bf16_fp4 v130, v180, 2.0 op_sel:[0,1,0]
  v_mfma_f32_16x16x32_bf16 v[56:59], a[224:227], a[144:147], v[200:203]
  v_cvt_scalef32_pk_bf16_fp4 v131, v180, 2.0 op_sel:[1,1,0]
  v_cvt_scalef32_pk_bf16_fp4 v136, v182, 2.0 op_sel:[0,0,0]
  v_mfma_f32_16x16x32_bf16 v[60:63], a[240:243], a[144:147], v[204:207]
  v_cvt_scalef32_pk_bf16_fp4 v137, v182, 2.0 op_sel:[1,0,0]
  v_cvt_scalef32_pk_bf16_fp4 v138, v182, 2.0 op_sel:[0,1,0]
  v_mfma_f32_16x16x32_bf16 v[56:59], a[228:231], a[148:151], v[56:59]
  v_cvt_scalef32_pk_bf16_fp4 v139, v182, 2.0 op_sel:[1,1,0]
  v_cvt_scalef32_pk_bf16_fp4 v140, v183, 2.0 op_sel:[0,0,0]
  v_mfma_f32_16x16x32_bf16 v[212:215], v[104:107], v[148:151], v[212:215]
  v_cvt_scalef32_pk_bf16_fp4 v141, v183, 2.0 op_sel:[1,0,0]
  v_cvt_scalef32_pk_bf16_fp4 v142, v183, 2.0 op_sel:[0,1,0]
  v_mfma_f32_16x16x32_bf16 v[60:63], a[244:247], a[148:151], v[60:63]
  v_exp_f32 v16, v16
  v_mfma_f32_16x16x32_bf16 v[56:59], a[232:235], a[152:155], v[56:59]
  v_exp_f32 v17, v17
  v_mfma_f32_16x16x32_bf16 a[96:99], v[108:111], v[144:147], a[96:99]
  v_cvt_scalef32_pk_bf16_fp4 v143, v183, 2.0 op_sel:[1,1,0]
  v_cvt_pk_bf16_f32 v80, v16, v17
  v_mfma_f32_16x16x32_bf16 v[60:63], a[248:251], a[152:155], v[60:63]
  v_exp_f32 v18, v18
  v_mfma_f32_16x16x32_bf16 v[60:63], a[252:255], a[156:159], v[60:63]
  v_exp_f32 v19, v19
  v_mfma_f32_16x16x32_bf16 v[208:211], v[104:107], v[144:147], v[208:211]
  s_waitcnt vmcnt(0)
  v_mfma_f32_16x16x32_bf16 a[100:103], v[108:111], v[148:151], a[100:103]
  buffer_store_dwordx4 a[68:71], v1, s[72:75], 0 offen offset:2176 sc1
  v_mfma_f32_16x16x32_bf16 v[216:219], v[104:107], v[152:155], v[216:219]
  v_cvt_scalef32_pk_bf16_fp4 v144, v184, 2.0 op_sel:[0,0,0]
  v_cvt_scalef32_pk_bf16_fp4 v145, v184, 2.0 op_sel:[1,0,0]
  v_mfma_f32_16x16x32_bf16 a[104:107], v[108:111], v[152:155], a[104:107]
  v_exp_f32 v60, v60
  v_mfma_f32_16x16x32_bf16 v[220:223], v[104:107], v[156:159], v[220:223]
  v_exp_f32 v61, v61
  v_mfma_f32_16x16x32_bf16 a[80:83], v[104:107], v[160:163], a[80:83]
  v_exp_f32 v62, v62
  v_mfma_f32_16x16x32_bf16 a[92:95], v[104:107], v[172:175], a[92:95]
  v_exp_f32 v63, v63
  v_mfma_f32_16x16x32_bf16 v[56:59], a[236:239], a[156:159], v[56:59]
  v_cvt_pk_bf16_f32 v102, v60, v61
  v_cvt_pk_bf16_f32 v103, v62, v63
  v_mfma_f32_16x16x32_bf16 a[124:127], v[108:111], v[172:175], a[124:127]
  v_cvt_scalef32_pk_bf16_fp4 v146, v184, 2.0 op_sel:[0,1,0]
  v_cvt_scalef32_pk_bf16_fp4 v147, v184, 2.0 op_sel:[1,1,0]
  v_mfma_f32_16x16x32_bf16 v[228:231], v[104:107], a[4:7], v[228:231]
  v_cvt_scalef32_pk_bf16_fp4 v148, v185, 2.0 op_sel:[0,0,0]
  v_cvt_scalef32_pk_bf16_fp4 v149, v185, 2.0 op_sel:[1,0,0]
  v_mfma_f32_16x16x32_bf16 a[112:115], v[108:111], v[160:163], a[112:115]
  v_exp_f32 v56, v56
  v_mfma_f32_16x16x32_bf16 a[84:87], v[104:107], v[164:167], a[84:87]
  v_exp_f32 v57, v57
  v_mfma_f32_16x16x32_bf16 a[116:119], v[108:111], v[164:167], a[116:119]
  v_exp_f32 v58, v58
  v_mfma_f32_16x16x32_bf16 a[88:91], v[104:107], v[168:171], a[88:91]
  v_exp_f32 v59, v59
  v_mfma_f32_16x16x32_bf16 a[120:123], v[108:111], v[168:171], a[120:123]
  v_cvt_pk_bf16_f32 v100, v56, v57
  v_cvt_pk_bf16_f32 v101, v58, v59
  v_mfma_f32_16x16x32_bf16 v[236:239], v[108:111], a[4:7], v[236:239]
  ds_read_b128 a[4:7], v5 offset:1904
  v_cvt_scalef32_pk_bf16_fp4 v150, v185, 2.0 op_sel:[0,1,0]
  v_mfma_f32_16x16x32_bf16 a[32:35], v[84:87], v[112:115], a[32:35]
  v_cvt_scalef32_pk_bf16_fp4 v151, v185, 2.0 op_sel:[1,1,0]
  v_cvt_scalef32_pk_bf16_fp4 v152, v186, 2.0 op_sel:[0,0,0]
  v_mfma_f32_16x16x32_bf16 a[36:39], v[84:87], v[116:119], a[36:39]
  v_cvt_scalef32_pk_bf16_fp4 v153, v186, 2.0 op_sel:[1,0,0]
  v_cvt_scalef32_pk_bf16_fp4 v154, v186, 2.0 op_sel:[0,1,0]
  v_mfma_f32_16x16x32_bf16 v[48:51], a[224:227], a[128:131], v[200:203]
  v_cvt_scalef32_pk_bf16_fp4 v155, v186, 2.0 op_sel:[1,1,0]
  v_cvt_scalef32_pk_bf16_fp4 v160, v188, 2.0 op_sel:[0,0,0]
  v_mfma_f32_16x16x32_bf16 a[108:111], v[108:111], v[156:159], a[108:111]
  v_cvt_scalef32_pk_bf16_fp4 v156, v187, 2.0 op_sel:[0,0,0]
  v_cvt_scalef32_pk_bf16_fp4 v157, v187, 2.0 op_sel:[1,0,0]
  v_mfma_f32_16x16x32_bf16 v[48:51], a[228:231], a[132:135], v[48:51]
  v_cvt_scalef32_pk_bf16_fp4 v158, v187, 2.0 op_sel:[0,1,0]
  v_cvt_scalef32_pk_bf16_fp4 v159, v187, 2.0 op_sel:[1,1,0]
  v_mfma_f32_16x16x32_bf16 a[40:43], v[84:87], v[120:123], a[40:43]
  v_cvt_scalef32_pk_bf16_fp4 v161, v188, 2.0 op_sel:[1,0,0]
  v_cvt_scalef32_pk_bf16_fp4 v162, v188, 2.0 op_sel:[0,1,0]
  v_mfma_f32_16x16x32_bf16 a[44:47], v[84:87], v[124:127], a[44:47]
  v_cvt_scalef32_pk_bf16_fp4 v163, v188, 2.0 op_sel:[1,1,0]
  v_cvt_scalef32_pk_bf16_fp4 v164, v189, 2.0 op_sel:[0,0,0]
  v_mfma_f32_16x16x32_bf16 v[48:51], a[232:235], a[136:139], v[48:51]
  v_cvt_scalef32_pk_bf16_fp4 v165, v189, 2.0 op_sel:[1,0,0]
  v_cvt_scalef32_pk_bf16_fp4 v166, v189, 2.0 op_sel:[0,1,0]
  v_mfma_f32_16x16x32_bf16 a[32:35], v[100:103], v[144:147], a[32:35]
  v_cvt_scalef32_pk_bf16_fp4 v167, v189, 2.0 op_sel:[1,1,0]
  v_cvt_scalef32_pk_bf16_fp4 v168, v190, 2.0 op_sel:[0,0,0]
  v_mfma_f32_16x16x32_bf16 v[48:51], a[236:239], a[140:143], v[48:51]
  v_cvt_scalef32_pk_bf16_fp4 v169, v190, 2.0 op_sel:[1,0,0]
  v_cvt_scalef32_pk_bf16_fp4 v170, v190, 2.0 op_sel:[0,1,0]
  v_mfma_f32_16x16x32_bf16 a[52:55], v[84:87], v[132:135], a[52:55]
  v_cvt_scalef32_pk_bf16_fp4 v171, v190, 2.0 op_sel:[1,1,0]
  v_cvt_pk_bf16_f32 v81, v18, v19
  v_mfma_f32_16x16x32_bf16 a[36:39], v[100:103], v[148:151], a[36:39]
  ds_write_b128 v6, a[32:35] offset:4096
  v_mfma_f32_16x16x32_bf16 v[52:55], a[240:243], a[128:131], v[204:207]
  v_exp_f32 v20, v20
  v_mfma_f32_16x16x32_bf16 a[40:43], v[100:103], v[152:155], a[40:43]
  v_exp_f32 v21, v21
  v_mfma_f32_16x16x32_bf16 a[48:51], v[84:87], v[128:131], a[48:51]
  v_exp_f32 v22, v22
  v_mfma_f32_16x16x32_bf16 a[56:59], v[84:87], v[136:139], a[56:59]
  ds_write_b128 v6, a[36:39] offset:5120
  v_mfma_f32_16x16x32_bf16 v[52:55], a[244:247], a[132:135], v[52:55]
  v_exp_f32 v23, v23
  v_mfma_f32_16x16x32_bf16 a[60:63], v[84:87], v[140:143], a[60:63]
  v_cvt_pk_bf16_f32 v82, v20, v21
  v_cvt_pk_bf16_f32 v83, v22, v23
  v_mfma_f32_16x16x32_bf16 a[44:47], v[100:103], v[156:159], a[44:47]
  ds_write_b128 v6, a[40:43] offset:6144
  v_mfma_f32_16x16x32_bf16 v[52:55], a[248:251], a[136:139], v[52:55]
  s_waitcnt lgkmcnt(4)
  v_cvt_scalef32_pk_bf16_fp4 v172, v191, 2.0 op_sel:[0,0,0]
  v_cvt_scalef32_pk_bf16_fp4 v173, v191, 2.0 op_sel:[1,0,0]
  v_mfma_f32_16x16x32_bf16 v[8:11], v[84:87], a[0:3], v[8:11]
  v_cvt_scalef32_pk_bf16_fp4 v174, v191, 2.0 op_sel:[0,1,0]
  v_cvt_scalef32_pk_bf16_fp4 v175, v191, 2.0 op_sel:[1,1,0]
  v_mfma_f32_16x16x32_bf16 a[48:51], v[100:103], v[160:163], a[48:51]
  ds_write_b128 v6, a[44:47] offset:7168
  v_mfma_f32_16x16x32_bf16 v[52:55], a[252:255], a[140:143], v[52:55]
  v_exp_f32 v48, v48
  v_mfma_f32_16x16x32_bf16 a[52:55], v[100:103], v[164:167], a[52:55]
  v_exp_f32 v49, v49
  v_mfma_f32_16x16x32_bf16 a[56:59], v[100:103], v[168:171], a[56:59]
  v_exp_f32 v50, v50
  v_mfma_f32_16x16x32_bf16 a[16:19], v[80:83], v[128:131], a[16:19]
  ds_write_b128 v6, a[48:51] offset:8192
  v_mfma_f32_16x16x32_bf16 a[60:63], v[100:103], v[172:175], a[60:63]
  s_waitcnt lgkmcnt(5)
  v_exp_f32 v51, v51
  v_mfma_f32_16x16x32_bf16 v[8:11], v[100:103], a[4:7], v[8:11]
  v_exp_f32 v52, v52
  v_mfma_f32_16x16x32_bf16 a[20:23], v[80:83], v[132:135], a[20:23]
  ds_write_b128 v6, a[52:55] offset:9216
  v_mfma_f32_16x16x32_bf16 a[24:27], v[80:83], v[136:139], a[24:27]
  v_exp_f32 v53, v53
  v_mfma_f32_16x16x32_bf16 a[28:31], v[80:83], v[140:143], a[28:31]
  v_exp_f32 v54, v54
  v_mfma_f32_16x16x32_bf16 v[224:227], v[80:83], a[0:3], v[224:227]
  ds_write_b128 v6, a[56:59] offset:10240
  v_mov_b32_dpp v8, v9 quad_perm:[0,1,2,3] row_mask:0xf bank_mask:0x2
  v_mov_b32_dpp v8, v10 quad_perm:[0,1,2,3] row_mask:0xf bank_mask:0x4
  v_mov_b32_dpp v8, v11 quad_perm:[0,1,2,3] row_mask:0xf bank_mask:0x8
  v_exp_f32 v55, v55
  v_cvt_pk_bf16_f32 v96, v48, v49
  v_cvt_pk_bf16_f32 v97, v50, v51
  v_cvt_pk_bf16_f32 v98, v52, v53
  v_cvt_pk_bf16_f32 v99, v54, v55
  s_nop 1
  v_mfma_f32_16x16x32_bf16 a[16:19], v[96:99], v[160:163], a[16:19]
  ds_write_b32 v13, v8 offset:0
  v_xor_b32 v13, 0x100, v13
  v_mfma_f32_16x16x32_bf16 v[40:43], a[192:195], a[176:179], v[192:195]
  ds_write_b128 v6, a[60:63] offset:11264
  v_mfma_f32_16x16x32_bf16 v[224:227], v[96:99], a[4:7], v[224:227]
  s_nop 1
  v_mfma_f32_16x16x32_bf16 v[40:43], a[196:199], a[180:183], v[40:43]
  s_nop 1
  v_mfma_f32_16x16x32_bf16 a[20:23], v[96:99], v[164:167], a[20:23]
  ds_write_b128 v6, a[16:19] offset:0
  v_mfma_f32_16x16x32_bf16 v[40:43], a[200:203], a[184:187], v[40:43]
  v_mov_b32_dpp v224, v225 quad_perm:[0,1,2,3] row_mask:0xf bank_mask:0x2
  v_mov_b32_dpp v224, v226 quad_perm:[0,1,2,3] row_mask:0xf bank_mask:0x4
  v_mov_b32_dpp v224, v227 quad_perm:[0,1,2,3] row_mask:0xf bank_mask:0x8
  v_mfma_f32_16x16x32_bf16 a[24:27], v[96:99], v[168:171], a[24:27]
  ds_write_b32 v13, v224 offset:0
  v_mfma_f32_16x16x32_bf16 v[40:43], a[204:207], a[188:191], v[40:43]
  ds_write_b128 v6, a[20:23] offset:1024
  v_mfma_f32_16x16x32_bf16 a[28:31], v[96:99], v[172:175], a[28:31]
  v_xor_b32 v13, 0x100, v13
  s_nop 0
  v_mfma_f32_16x16x32_bf16 v[44:47], a[208:211], a[176:179], v[196:199]
  s_nop 1
  v_mfma_f32_16x16x32_bf16 v[44:47], a[212:215], a[180:183], v[44:47]
  ds_write_b128 v6, a[24:27] offset:2048
  v_mfma_f32_16x16x32_bf16 v[44:47], a[216:219], a[184:187], v[44:47]
  v_exp_f32 v40, v40
  v_mfma_f32_16x16x32_bf16 v[44:47], a[220:223], a[188:191], v[44:47]
  v_exp_f32 v41, v41
  v_mfma_f32_16x16x32_bf16 v[240:243], v[80:83], v[112:115], v[240:243]
  ds_write_b128 v6, a[28:31] offset:3072
  v_mfma_f32_16x16x32_bf16 v[240:243], v[96:99], v[144:147], v[240:243]
  v_exp_f32 v42, v42
  v_mfma_f32_16x16x32_bf16 v[244:247], v[80:83], v[116:119], v[244:247]
  v_exp_f32 v43, v43
  v_mfma_f32_16x16x32_bf16 v[244:247], v[96:99], v[148:151], v[244:247]
  v_exp_f32 v44, v44
  v_mfma_f32_16x16x32_bf16 v[248:251], v[80:83], v[120:123], v[248:251]
  v_exp_f32 v45, v45
  v_mfma_f32_16x16x32_bf16 v[248:251], v[96:99], v[152:155], v[248:251]
  v_exp_f32 v46, v46
  v_mfma_f32_16x16x32_bf16 v[72:75], a[224:227], a[176:179], v[200:203]
  v_exp_f32 v47, v47
  v_mfma_f32_16x16x32_bf16 v[76:79], a[240:243], a[176:179], v[204:207]
  v_cvt_pk_bf16_f32 v92, v40, v41
  v_cvt_pk_bf16_f32 v93, v42, v43
  v_mfma_f32_16x16x32_bf16 v[76:79], a[244:247], a[180:183], v[76:79]
  s_waitcnt lgkmcnt(0)
  s_barrier
  v_cvt_pk_bf16_f32 v94, v44, v45
  v_mfma_f32_16x16x32_bf16 v[76:79], a[248:251], a[184:187], v[76:79]
  ds_read_b128 v[16:19], v233 offset:0
  ds_read_b128 v[20:23], v233 offset:1024
  v_mfma_f32_16x16x32_bf16 v[76:79], a[252:255], a[188:191], v[76:79]
  buffer_load_dword v14, off, s[76:79], 0 offset:2176 sc1
  ds_read_b128 v[24:27], v233 offset:2048
  v_mfma_f32_16x16x32_bf16 v[72:75], a[228:231], a[180:183], v[72:75]
  v_cvt_pk_bf16_f32 v95, v46, v47
  s_nop 0
  v_mfma_f32_16x16x32_bf16 v[252:255], v[80:83], v[124:127], v[252:255]
  ds_read_b128 v[28:31], v233 offset:3072
  ds_read_b128 v[48:51], v234 offset:4096
  v_mfma_f32_16x16x32_bf16 v[252:255], v[96:99], v[156:159], v[252:255]
  v_exp_f32 v76, v76
  v_mfma_f32_16x16x32_bf16 v[72:75], a[232:235], a[184:187], v[72:75]
  ds_read_b128 v[52:55], v234 offset:5120
  ds_read_b128 v[56:59], v234 offset:6144
  v_mfma_f32_16x16x32_bf16 v[72:75], a[236:239], a[188:191], v[72:75]
  v_exp_f32 v77, v77
  v_mfma_f32_16x16x32_bf16 v[32:35], a[192:195], a[160:163], v[192:195]
  ds_read_b128 v[60:63], v234 offset:7168
  ds_read_b128 v[176:179], v235 offset:8192
  v_mfma_f32_16x16x32_bf16 v[32:35], a[196:199], a[164:167], v[32:35]
  v_exp_f32 v78, v78
  v_mfma_f32_16x16x32_bf16 v[32:35], a[200:203], a[168:171], v[32:35]
  ds_read_b128 v[180:183], v235 offset:9216
  ds_read_b128 v[184:187], v235 offset:10240
  v_mfma_f32_16x16x32_bf16 v[36:39], a[208:211], a[160:163], v[196:199]
  v_exp_f32 v72, v72
  v_mfma_f32_16x16x32_bf16 v[36:39], a[212:215], a[164:167], v[36:39]
  ds_read_b128 v[188:191], v235 offset:11264
  ds_read_b128 v[224:227], v7 offset:0
  v_mfma_f32_16x16x32_bf16 v[36:39], a[216:219], a[168:171], v[36:39]
  v_exp_f32 v73, v73
  v_mfma_f32_16x16x32_bf16 v[36:39], a[220:223], a[172:175], v[36:39]
  ds_read_b128 v[80:83], v7 offset:512
  ds_read_b128 v[84:87], v7 offset:1024
  v_mfma_f32_16x16x32_bf16 v[64:67], a[224:227], a[160:163], v[200:203]
  v_exp_f32 v74, v74
  v_mfma_f32_16x16x32_bf16 v[64:67], a[228:231], a[164:167], v[64:67]
  ds_read_b128 v[96:99], v7 offset:1536
  v_cvt_pk_bf16_f32 v108, v72, v73
  v_mfma_f32_16x16x32_bf16 a[104:107], v[92:95], v[120:123], a[104:107]
  v_exp_f32 v75, v75
  v_mfma_f32_16x16x32_bf16 v[64:67], a[232:235], a[168:171], v[64:67]
  v_exp_f32 v79, v79
  v_mfma_f32_16x16x32_bf16 v[32:35], a[204:207], a[172:175], v[32:35]
  v_cvt_pk_bf16_f32 v109, v74, v75
  v_cvt_pk_bf16_f32 v110, v76, v77
  v_mfma_f32_16x16x32_bf16 v[64:67], a[236:239], a[172:175], v[64:67]
  v_exp_f32 v36, v36
  v_mfma_f32_16x16x32_bf16 v[68:71], a[240:243], a[160:163], v[204:207]
  v_exp_f32 v37, v37
  v_mfma_f32_16x16x32_bf16 v[68:71], a[244:247], a[164:167], v[68:71]
  v_cvt_pk_bf16_f32 v111, v78, v79
  v_cvt_pk_bf16_f32 v90, v36, v37
  v_mfma_f32_16x16x32_bf16 a[96:99], v[92:95], v[112:115], a[96:99]
  v_exp_f32 v32, v32
  v_mfma_f32_16x16x32_bf16 a[96:99], v[108:111], v[144:147], a[96:99]
  s_waitcnt lgkmcnt(0)
  .p2align 3
  v_pk_add_f32 v[224:225], v[224:225], v[80:81]
  v_pk_add_f32 v[84:85], v[84:85], v[96:97]
  v_pk_add_f32 v[226:227], v[226:227], v[82:83]
  v_pk_add_f32 v[86:87], v[86:87], v[98:99]
  v_pk_add_f32 v[240:241], v[240:241], v[16:17]
  v_pk_add_f32 v[242:243], v[242:243], v[18:19]
  v_pk_add_f32 v[244:245], v[244:245], v[20:21]
  v_pk_add_f32 v[246:247], v[246:247], v[22:23]
  v_pk_add_f32 v[248:249], v[248:249], v[24:25]
  v_pk_add_f32 v[250:251], v[250:251], v[26:27]
  v_pk_add_f32 v[252:253], v[252:253], v[28:29]
  v_pk_add_f32 v[254:255], v[254:255], v[30:31]
  v_pk_add_f32 v[224:225], v[224:225], v[84:85]
  v_pk_add_f32 v[226:227], v[226:227], v[86:87]
  v_pk_add_f32 v[48:49], v[48:49], v[176:177]
  v_pk_add_f32 v[50:51], v[50:51], v[178:179]
  v_pk_add_f32 v[52:53], v[52:53], v[180:181]
  v_pk_add_f32 v[54:55], v[54:55], v[182:183]
  v_pk_add_f32 v[56:57], v[56:57], v[184:185]
  v_pk_add_f32 v[58:59], v[58:59], v[186:187]
  v_pk_add_f32 v[60:61], v[60:61], v[188:189]
  v_pk_add_f32 v[62:63], v[62:63], v[190:191]
  v_pk_add_f32 v[240:241], v[240:241], v[48:49]
  v_pk_add_f32 v[242:243], v[242:243], v[50:51]
  v_pk_add_f32 v[244:245], v[244:245], v[52:53]
  v_pk_add_f32 v[246:247], v[246:247], v[54:55]
  v_pk_add_f32 v[248:249], v[248:249], v[56:57]
  v_pk_add_f32 v[250:251], v[250:251], v[58:59]
  v_pk_add_f32 v[252:253], v[252:253], v[60:61]
  v_pk_add_f32 v[254:255], v[254:255], v[62:63]
  v_mov_b32_dpp v96, v224 quad_perm:[2,2,2,2] row_mask:0xf bank_mask:0xf
  v_mov_b32_dpp v97, v225 quad_perm:[2,2,2,2] row_mask:0xf bank_mask:0xf
  v_mov_b32_dpp v98, v226 quad_perm:[2,2,2,2] row_mask:0xf bank_mask:0xf
  v_mov_b32_dpp v99, v227 quad_perm:[2,2,2,2] row_mask:0xf bank_mask:0xf
  v_pk_add_f32 v[240:241], v[240:241], v[96:97] neg_lo:[0,1] neg_hi:[0,1]
  v_pk_add_f32 v[242:243], v[242:243], v[98:99] neg_lo:[0,1] neg_hi:[0,1]
  v_pk_add_f32 v[244:245], v[244:245], v[96:97] neg_lo:[0,1] neg_hi:[0,1]
  v_pk_add_f32 v[246:247], v[246:247], v[98:99] neg_lo:[0,1] neg_hi:[0,1]
  v_pk_add_f32 v[248:249], v[248:249], v[96:97] neg_lo:[0,1] neg_hi:[0,1]
  v_pk_add_f32 v[250:251], v[250:251], v[98:99] neg_lo:[0,1] neg_hi:[0,1]
  v_pk_add_f32 v[252:253], v[252:253], v[96:97] neg_lo:[0,1] neg_hi:[0,1]
  v_pk_add_f32 v[254:255], v[254:255], v[98:99] neg_lo:[0,1] neg_hi:[0,1]
  v_mfma_f32_16x16x32_bf16 a[100:103], v[92:95], v[116:119], a[100:103]
  v_cvt_pk_bf16_f32 v16, v240, v244
  v_cvt_pk_bf16_f32 v17, v248, v252
  v_cvt_pk_bf16_f32 v18, v241, v245
  v_cvt_pk_bf16_f32 v19, v249, v253
  v_cvt_pk_bf16_f32 v20, v242, v246
  v_cvt_pk_bf16_f32 v21, v250, v254
  v_cvt_pk_bf16_f32 v22, v243, v247
  v_cvt_pk_bf16_f32 v23, v251, v255
  v_add_f32_dpp v80, v224, v224 quad_perm:[1,0,3,2] row_mask:0xf bank_mask:0xf
  v_mfma_f32_16x16x32_bf16 a[100:103], v[108:111], v[148:151], a[100:103]
  buffer_store_dwordx4 v[16:19], v1, s[72:75], 0 offen offset:0 sc1
  buffer_store_dwordx4 v[20:23], v1, s[72:75], 0 offen offset:1024 sc1
  v_add_f32_dpp v81, v225, v225 quad_perm:[1,0,3,2] row_mask:0xf bank_mask:0xf
  v_mfma_f32_16x16x32_bf16 a[104:107], v[108:111], v[152:155], a[104:107]
  v_add_f32_dpp v82, v226, v226 quad_perm:[1,0,3,2] row_mask:0xf bank_mask:0xf
  v_add_f32_dpp v83, v227, v227 quad_perm:[1,0,3,2] row_mask:0xf bank_mask:0xf
  v_mfma_f32_16x16x32_bf16 v[68:71], a[248:251], a[168:171], v[68:71]
  buffer_store_dwordx4 v[80:83], v15, s[72:75], 0 offen offset:2048 sc1
  v_mfma_f32_16x16x32_bf16 v[68:71], a[252:255], a[172:175], v[68:71]
  ds_write_b128 v6, a[96:99] offset:16384
  v_mfma_f32_16x16x32_bf16 a[112:115], v[92:95], v[128:131], a[112:115]
  v_exp_f32 v33, v33
  v_mfma_f32_16x16x32_bf16 a[112:115], v[108:111], v[160:163], a[112:115]
  v_exp_f32 v34, v34
  v_mfma_f32_16x16x32_bf16 a[108:111], v[92:95], v[124:127], a[108:111]
  ds_write_b128 v6, a[100:103] offset:17408
  v_mfma_f32_16x16x32_bf16 a[108:111], v[108:111], v[156:159], a[108:111]
  v_exp_f32 v35, v35
  v_mfma_f32_16x16x32_bf16 a[116:119], v[92:95], v[132:135], a[116:119]
  v_exp_f32 v38, v38
  v_mfma_f32_16x16x32_bf16 a[116:119], v[108:111], v[164:167], a[116:119]
  ds_write_b128 v6, a[104:107] offset:18432
  v_exp_f32 v39, v39
  v_cvt_pk_bf16_f32 v88, v32, v33
  v_cvt_pk_bf16_f32 v89, v34, v35
  v_cvt_pk_bf16_f32 v91, v38, v39
  v_exp_f32 v64, v64
  v_exp_f32 v65, v65
  v_mfma_f32_16x16x32_bf16 a[80:83], v[88:91], v[128:131], a[80:83]
  ds_write_b128 v6, a[108:111] offset:19456
  v_mfma_f32_16x16x32_bf16 a[120:123], v[92:95], v[136:139], a[120:123]
  v_exp_f32 v66, v66
  v_mfma_f32_16x16x32_bf16 a[120:123], v[108:111], v[168:171], a[120:123]
  v_exp_f32 v67, v67
  v_mfma_f32_16x16x32_bf16 a[88:91], v[88:91], v[136:139], a[88:91]
  ds_write_b128 v6, a[112:115] offset:20480
  v_mfma_f32_16x16x32_bf16 a[84:87], v[88:91], v[132:135], a[84:87]
  v_exp_f32 v68, v68
  v_mfma_f32_16x16x32_bf16 a[124:127], v[92:95], v[140:143], a[124:127]
  v_exp_f32 v69, v69
  v_mfma_f32_16x16x32_bf16 a[92:95], v[88:91], v[140:143], a[92:95]
  ds_write_b128 v6, a[116:119] offset:21504
  v_mfma_f32_16x16x32_bf16 a[124:127], v[108:111], v[172:175], a[124:127]
  v_exp_f32 v70, v70
  v_mfma_f32_16x16x32_bf16 v[228:231], v[88:91], a[0:3], v[228:231]
  v_exp_f32 v71, v71
  v_mfma_f32_16x16x32_bf16 v[236:239], v[92:95], a[0:3], v[236:239]
  ds_write_b128 v6, a[120:123] offset:22528
  v_mfma_f32_16x16x32_bf16 v[236:239], v[108:111], a[4:7], v[236:239]
  v_cvt_pk_bf16_f32 v104, v64, v65
  v_cvt_pk_bf16_f32 v105, v66, v67
  v_cvt_pk_bf16_f32 v106, v68, v69
  v_cvt_pk_bf16_f32 v107, v70, v71
  s_nop 1
  v_mfma_f32_16x16x32_bf16 a[80:83], v[104:107], v[160:163], a[80:83]
  ds_write_b128 v6, a[124:127] offset:23552
  v_mfma_f32_16x16x32_bf16 v[228:231], v[104:107], a[4:7], v[228:231]
  v_mov_b32_dpp v236, v237 quad_perm:[0,1,2,3] row_mask:0xf bank_mask:0x2
  v_mov_b32_dpp v236, v238 quad_perm:[0,1,2,3] row_mask:0xf bank_mask:0x4
  v_mfma_f32_16x16x32_bf16 a[84:87], v[104:107], v[164:167], a[84:87]
  v_mov_b32_dpp v236, v239 quad_perm:[0,1,2,3] row_mask:0xf bank_mask:0x8
  s_nop 0
  v_mfma_f32_16x16x32_bf16 a[88:91], v[104:107], v[168:171], a[88:91]
  ds_write_b32 v13, v236 offset:2048
  v_mfma_f32_16x16x32_bf16 a[92:95], v[104:107], v[172:175], a[92:95]
  ds_write_b128 v6, a[80:83] offset:12288
  v_mfma_f32_16x16x32_bf16 v[208:211], v[88:91], v[112:115], v[208:211]
  v_mov_b32_dpp v228, v229 quad_perm:[0,1,2,3] row_mask:0xf bank_mask:0x2
  v_mov_b32_dpp v228, v230 quad_perm:[0,1,2,3] row_mask:0xf bank_mask:0x4
  v_mfma_f32_16x16x32_bf16 v[216:219], v[88:91], v[120:123], v[216:219]
  v_mov_b32_dpp v228, v231 quad_perm:[0,1,2,3] row_mask:0xf bank_mask:0x8
  v_xor_b32 v13, 0x100, v13
  v_mfma_f32_16x16x32_bf16 v[216:219], v[104:107], v[152:155], v[216:219]
  ds_write_b128 v6, a[84:87] offset:13312
  v_mfma_f32_16x16x32_bf16 v[220:223], v[88:91], v[124:127], v[220:223]
  v_mfma_f32_16x16x32_bf16 v[208:211], v[104:107], v[144:147], v[208:211]
  v_mfma_f32_16x16x32_bf16 v[212:215], v[88:91], v[116:119], v[212:215]
  ds_write_b128 v6, a[88:91] offset:14336
  v_mfma_f32_16x16x32_bf16 v[212:215], v[104:107], v[148:151], v[212:215]
  v_mfma_f32_16x16x32_bf16 v[220:223], v[104:107], v[156:159], v[220:223]
  ds_write_b128 v6, a[92:95] offset:15360
  ds_write_b32 v13, v228 offset:2048
LA_sent:
  s_mov_b32 s50, 0
  s_waitcnt vmcnt(3)
  buffer_load_dwordx4 v[176:179], v1, s[76:79], 0 offen sc1
  buffer_load_dwordx4 v[180:183], v1, s[76:79], 0 offen offset:1024 sc1
  buffer_load_dwordx4 v[184:187], v12, s[76:79], 0 offen offset:2048 sc1
  v_cmp_ne_u32 vcc, s49, v14
  s_waitcnt lgkmcnt(0)
  s_barrier
  ds_read_b128 v[228:231], v7 offset:2048
  ds_read_b128 v[80:83], v7 offset:2560
  ds_read_b128 v[84:87], v7 offset:3072
  ds_read_b128 v[88:91], v7 offset:3584
  ds_read_b128 v[16:19], v233 offset:12288
  ds_read_b128 v[20:23], v233 offset:13312
  ds_read_b128 v[24:27], v233 offset:14336
  ds_read_b128 v[28:31], v233 offset:15360
  ds_read_b128 v[48:51], v234 offset:16384
  ds_read_b128 v[52:55], v234 offset:17408
  ds_read_b128 v[56:59], v234 offset:18432
  ds_read_b128 v[60:63], v234 offset:19456
  ds_read_b128 v[240:243], v235 offset:20480
  ds_read_b128 v[244:247], v235 offset:21504
  ds_read_b128 v[248:251], v235 offset:22528
  ds_read_b128 v[252:255], v235 offset:23552
  s_waitcnt lgkmcnt(12)
  v_pk_add_f32 v[228:229], v[228:229], v[80:81]
  v_pk_add_f32 v[230:231], v[230:231], v[82:83]
  v_pk_add_f32 v[84:85], v[84:85], v[88:89]
  v_pk_add_f32 v[86:87], v[86:87], v[90:91]
  v_pk_add_f32 v[228:229], v[228:229], v[84:85]
  v_pk_add_f32 v[230:231], v[230:231], v[86:87]
  s_waitcnt lgkmcnt(8)
  v_pk_add_f32 v[208:209], v[208:209], v[16:17]
  v_pk_add_f32 v[210:211], v[210:211], v[18:19]
  v_pk_add_f32 v[212:213], v[212:213], v[20:21]
  v_pk_add_f32 v[214:215], v[214:215], v[22:23]
  v_pk_add_f32 v[216:217], v[216:217], v[24:25]
  v_pk_add_f32 v[218:219], v[218:219], v[26:27]
  v_pk_add_f32 v[220:221], v[220:221], v[28:29]
  v_pk_add_f32 v[222:223], v[222:223], v[30:31]
  v_mov_b32_dpp v80, v228 quad_perm:[2,2,2,2] row_mask:0xf bank_mask:0xf
  v_mov_b32_dpp v81, v229 quad_perm:[2,2,2,2] row_mask:0xf bank_mask:0xf
  v_mov_b32_dpp v82, v230 quad_perm:[2,2,2,2] row_mask:0xf bank_mask:0xf
  v_mov_b32_dpp v83, v231 quad_perm:[2,2,2,2] row_mask:0xf bank_mask:0xf
  v_mov_b32_dpp v84, v228 quad_perm:[1,1,1,1] row_mask:0xf bank_mask:0xf
  v_mov_b32_dpp v85, v229 quad_perm:[1,1,1,1] row_mask:0xf bank_mask:0xf
  v_mov_b32_dpp v86, v230 quad_perm:[1,1,1,1] row_mask:0xf bank_mask:0xf
  v_mov_b32_dpp v87, v231 quad_perm:[1,1,1,1] row_mask:0xf bank_mask:0xf
  v_add_f32_dpp v84, v228, v84 quad_perm:[0,0,0,0] row_mask:0xf bank_mask:0xf
  v_add_f32_dpp v85, v229, v85 quad_perm:[0,0,0,0] row_mask:0xf bank_mask:0xf
  v_add_f32_dpp v86, v230, v86 quad_perm:[0,0,0,0] row_mask:0xf bank_mask:0xf
  v_add_f32_dpp v87, v231, v87 quad_perm:[0,0,0,0] row_mask:0xf bank_mask:0xf
  v_pk_add_f32 v[208:209], v[208:209], v[80:81] neg_lo:[0,1] neg_hi:[0,1]
  v_pk_add_f32 v[210:211], v[210:211], v[82:83] neg_lo:[0,1] neg_hi:[0,1]
  v_pk_add_f32 v[212:213], v[212:213], v[80:81] neg_lo:[0,1] neg_hi:[0,1]
  v_pk_add_f32 v[214:215], v[214:215], v[82:83] neg_lo:[0,1] neg_hi:[0,1]
  v_pk_add_f32 v[216:217], v[216:217], v[80:81] neg_lo:[0,1] neg_hi:[0,1]
  v_pk_add_f32 v[218:219], v[218:219], v[82:83] neg_lo:[0,1] neg_hi:[0,1]
  v_pk_add_f32 v[220:221], v[220:221], v[80:81] neg_lo:[0,1] neg_hi:[0,1]
  v_pk_add_f32 v[222:223], v[222:223], v[82:83] neg_lo:[0,1] neg_hi:[0,1]
  s_waitcnt lgkmcnt(0)
  s_nop 0
  v_pk_add_f32 v[48:49], v[48:49], v[240:241]
  v_pk_add_f32 v[50:51], v[50:51], v[242:243]
  v_pk_add_f32 v[52:53], v[52:53], v[244:245]
  v_pk_add_f32 v[54:55], v[54:55], v[246:247]
  v_pk_add_f32 v[56:57], v[56:57], v[248:249]
  v_pk_add_f32 v[58:59], v[58:59], v[250:251]
  v_pk_add_f32 v[60:61], v[60:61], v[252:253]
  v_pk_add_f32 v[62:63], v[62:63], v[254:255]
  v_pk_add_f32 v[208:209], v[208:209], v[48:49]
  v_pk_add_f32 v[210:211], v[210:211], v[50:51]
  v_pk_add_f32 v[212:213], v[212:213], v[52:53]
  v_pk_add_f32 v[214:215], v[214:215], v[54:55]
  v_pk_add_f32 v[216:217], v[216:217], v[56:57]
  v_pk_add_f32 v[218:219], v[218:219], v[58:59]
  v_pk_add_f32 v[220:221], v[220:221], v[60:61]
  v_pk_add_f32 v[222:223], v[222:223], v[62:63]
  s_cbranch_vccnz LA_cwait
LA_rchk:
  s_waitcnt vmcnt(0)
LA_rchk2:
  v_max3_u32 v92, v176, v177, v178
  v_max3_u32 v93, v179, v180, v181
  v_max3_u32 v92, v92, v182, v183
  v_max3_u32 v93, v93, v184, v185
  v_max3_u32 v92, v92, v186, v187
  v_max_u32 v92, v92, v93
  v_cmp_eq_u32 vcc, -1, v92
  v_pk_add_f32 v[188:189], v[184:185], v[84:85]
  v_pk_add_f32 v[190:191], v[186:187], v[86:87]
  s_cbranch_vccnz LA_again
  v_rcp_f32 v88, v188
  v_rcp_f32 v89, v189
  v_lshlrev_b32 v112, 16, v176
  v_and_b32 v116, 0xffff0000, v176
  v_lshlrev_b32 v120, 16, v177
  v_and_b32 v124, 0xffff0000, v177
  v_lshlrev_b32 v113, 16, v178
  v_and_b32 v117, 0xffff0000, v178
  v_lshlrev_b32_e64 v121, 16, v179
  v_and_b32 v125, 0xffff0000, v179
  v_pk_add_f32 v[112:113], v[112:113], v[208:209]
  v_pk_add_f32 v[116:117], v[116:117], v[212:213]
  v_pk_add_f32 v[120:121], v[120:121], v[216:217]
  v_pk_add_f32 v[124:125], v[124:125], v[220:221]
  v_pk_mul_f32 v[112:113], v[112:113], v[88:89]
  v_pk_mul_f32 v[116:117], v[116:117], v[88:89]
  v_pk_mul_f32 v[120:121], v[120:121], v[88:89]
  v_pk_mul_f32 v[124:125], v[124:125], v[88:89]
  v_cvt_pk_bf16_f32 v128, v112, v116
  v_cvt_pk_bf16_f32 v129, v120, v124
  v_cvt_pk_bf16_f32 v130, v113, v117
  v_cvt_pk_bf16_f32 v131, v121, v125
  buffer_store_dwordx2 v[128:129], v0, s[36:39], s3 offen offset:0 sc1
  buffer_store_dwordx2 v[130:131], v0, s[36:39], s3 offen offset:256 sc1
  v_rcp_f32 v90, v190
  v_rcp_f32 v91, v191
  v_lshlrev_b32 v114, 16, v180
  v_and_b32 v118, 0xffff0000, v180
  v_lshlrev_b32 v122, 16, v181
  v_and_b32 v126, 0xffff0000, v181
  v_lshlrev_b32 v115, 16, v182
  v_and_b32 v119, 0xffff0000, v182
  v_lshlrev_b32 v123, 16, v183
  v_and_b32 v127, 0xffff0000, v183
  v_pk_add_f32 v[114:115], v[114:115], v[210:211]
  v_pk_add_f32 v[118:119], v[118:119], v[214:215]
  v_pk_add_f32 v[122:123], v[122:123], v[218:219]
  v_pk_add_f32 v[126:127], v[126:127], v[222:223]
  v_pk_mul_f32 v[114:115], v[114:115], v[90:91]
  v_pk_mul_f32 v[118:119], v[118:119], v[90:91]
  v_pk_mul_f32 v[122:123], v[122:123], v[90:91]
  v_pk_mul_f32 v[126:127], v[126:127], v[90:91]
  v_cvt_pk_bf16_f32 v132, v114, v118
  v_cvt_pk_bf16_f32 v133, v122, v126
  v_cvt_pk_bf16_f32 v134, v115, v119
  v_cvt_pk_bf16_f32 v135, v123, v127
  buffer_store_dwordx2 v[132:133], v0, s[36:39], s3 offen offset:512 sc1
  buffer_store_dwordx2 v[134:135], v0, s[36:39], s3 offen offset:768 sc1
  v_min3_f32 v94, v188, v189, v190
  v_max3_f32 v95, v188, v189, v190
  v_min_f32 v94, v94, v191
  v_max_f32 v95, v95, v191
  v_pk_add_f32 v[112:113], v[112:113], v[114:115]
  v_cmp_nle_f32 vcc, s56, v94
  v_cmp_nge_f32 s[52:53], s57, v95
  v_add_f32 v112, v112, v113
  v_cmp_class_f32 s[50:51], v112, s58
  s_or_b64 vcc, vcc, s[52:53]
  s_or_b64 vcc, vcc, s[50:51]
  s_cbranch_vccnz LA_fallback
LA_end:
  s_endpgm
LA_fast:
  s_mov_b64 exec, -1
  buffer_load_dwordx4 a[192:195], v1, s[60:63], 0 offen offset:0 sc1
  buffer_load_dwordx4 a[196:199], v1, s[60:63], 0 offen offset:1024 sc1
  buffer_load_dwordx4 a[200:203], v1, s[60:63], 0 offen offset:2048 sc1
  buffer_load_dwordx4 a[204:207], v1, s[60:63], 0 offen offset:3072 sc1
  buffer_load_dwordx4 a[208:211], v2, s[60:63], 0 offen offset:0 sc1
  buffer_load_dwordx4 a[212:215], v2, s[60:63], 0 offen offset:1024 sc1
  buffer_load_dwordx4 a[216:219], v2, s[60:63], 0 offen offset:2048 sc1
  buffer_load_dwordx4 a[220:223], v2, s[60:63], 0 offen offset:3072 sc1
  v_lshlrev_b32 v136, 16, v104
  v_and_b32 v137, 0xffff0000, v104
  v_lshlrev_b32 v138, 16, v105
  v_and_b32 v139, 0xffff0000, v105
  v_lshlrev_b32 v140, 16, v106
  v_and_b32 v141, 0xffff0000, v106
  v_lshlrev_b32 v142, 16, v107
  v_and_b32 v143, 0xffff0000, v107
  v_lshlrev_b32 v144, 16, v108
  v_and_b32 v145, 0xffff0000, v108
  v_lshlrev_b32 v146, 16, v109
  v_and_b32 v147, 0xffff0000, v109
  v_lshlrev_b32 v148, 16, v110
  v_and_b32 v149, 0xffff0000, v110
  v_lshlrev_b32 v150, 16, v111
  v_and_b32 v151, 0xffff0000, v111
  v_pk_mul_f32 v[120:121], v[136:137], v[64:65]
  v_pk_mul_f32 v[122:123], v[144:145], v[64:65]
  v_pk_fma_f32 v[120:121], v[144:145], v[72:73], v[120:121] neg_lo:[1,0,0] neg_hi:[1,0,0]
  v_pk_fma_f32 v[122:123], v[136:137], v[72:73], v[122:123]
  v_cvt_pk_bf16_f32 v104, v120, v121
  v_cvt_pk_bf16_f32 v108, v122, v123
  v_pk_mul_f32 v[124:125], v[138:139], v[66:67]
  v_pk_mul_f32 v[126:127], v[146:147], v[66:67]
  v_pk_fma_f32 v[124:125], v[146:147], v[74:75], v[124:125] neg_lo:[1,0,0] neg_hi:[1,0,0]
  v_pk_fma_f32 v[126:127], v[138:139], v[74:75], v[126:127]
  v_cvt_pk_bf16_f32 v105, v124, v125
  v_cvt_pk_bf16_f32 v109, v126, v127
  v_pk_mul_f32 v[120:121], v[140:141], v[68:69]
  v_pk_mul_f32 v[122:123], v[148:149], v[68:69]
  v_pk_fma_f32 v[120:121], v[148:149], v[76:77], v[120:121] neg_lo:[1,0,0] neg_hi:[1,0,0]
  v_pk_fma_f32 v[122:123], v[140:141], v[76:77], v[122:123]
  v_cvt_pk_bf16_f32 v106, v120, v121
  v_cvt_pk_bf16_f32 v110, v122, v123
  v_pk_mul_f32 v[124:125], v[142:143], v[70:71]
  v_pk_mul_f32 v[126:127], v[150:151], v[70:71]
  v_pk_fma_f32 v[124:125], v[150:151], v[78:79], v[124:125] neg_lo:[1,0,0] neg_hi:[1,0,0]
  v_pk_fma_f32 v[126:127], v[142:143], v[78:79], v[126:127]
  v_cvt_pk_bf16_f32 v107, v124, v125
  v_cvt_pk_bf16_f32 v111, v126, v127
  ds_write_b128 v166, v[104:107] offset:0
  ds_write_b128 v166, v[108:111] offset:4224
  s_waitcnt lgkmcnt(0)
  s_barrier
  ds_read_b128 a[128:131], v167 offset:0
  ds_read_b128 a[144:147], v168 offset:0
  ds_read_b128 a[132:135], v167 offset:2112
  ds_read_b128 a[148:151], v168 offset:2112
  ds_read_b128 a[136:139], v167 offset:4224
  ds_read_b128 a[152:155], v168 offset:4224
  ds_read_b128 a[140:143], v167 offset:6336
  ds_read_b128 a[156:159], v168 offset:6336
  s_branch LA_go
LA_cwait:
  buffer_load_dword v14, off, s[76:79], 0 offset:2176 sc1
  s_add_u32 s50, s50, 1
  s_waitcnt vmcnt(0)
  v_cmp_ne_u32 vcc, s49, v14
  s_cbranch_vccz LA_again
  s_cmp_lt_u32 s50, 8000
  s_cbranch_scc1 LA_cwait
  s_branch LA_fallback
LA_again:
  buffer_load_dwordx4 v[176:179], v1, s[76:79], 0 offen sc1
  buffer_load_dwordx4 v[180:183], v1, s[76:79], 0 offen offset:1024 sc1
  buffer_load_dwordx4 v[184:187], v12, s[76:79], 0 offen offset:2048 sc1
  s_add_u32 s50, s50, 1
  s_cmp_lt_u32 s50, 16000
  s_cbranch_scc1 LA_rchk
  s_branch LA_fallback
LA_poison:
  v_mov_b32 v17, 0x7fc07fc0
  s_waitcnt vmcnt(0)
  global_store_dword v164, v17, s[32:33] sc1
  s_waitcnt vmcnt(0)
  s_branch LA_clean
LA_mktag:
  s_or_b32 s49, s68, 1
  v_mov_b32 v118, s49
  s_mov_b64 exec, 1
  global_atomic_cmpswap v117, v119, v[118:119], s[52:53] sc0 sc1
  s_waitcnt vmcnt(0)
  v_readfirstlane_b32 s51, v117
  s_mov_b64 exec, -1
  s_cmp_eq_u32 s51, 0
  s_cselect_b32 s49, s49, s51
  v_mov_b32 v118, s49
  s_branch LA_tagged
LA_blk0:
  s_mov_b64 exec, 255
  s_mov_b32 s50, s44
LA_p10:
  s_cmp_ge_u32 s50, 10
  s_cbranch_scc1 LA_p20
  global_load_dword v14, v161, s[28:29] offset:0 sc1
  s_add_u32 s50, s50, 1
  s_waitcnt vmcnt(0)
  v_cmp_ne_u32 vcc, s49, v14
  s_cbranch_vccnz LA_p10
LA_pe0:
  s_mov_b64 exec, -1
  s_branch LA_ret0
LA_p20:
  s_mov_b32 s44, 10
  global_load_dword v14, v161, s[28:29] offset:128 sc1
  s_add_u32 s50, s50, 1
  s_waitcnt vmcnt(0)
  v_cmp_ne_u32 vcc, s49, v14
  s_cbranch_vccz LA_pe0
  s_sleep 2
  s_cmp_lt_u32 s50, 8000
  s_cbranch_scc1 LA_p20
  v_mov_b32 v14, 0x7fc00000
  ds_write_b32 v4, v14 offset:896
  s_mov_b32 s62, 0
  s_mov_b32 s66, 0
  s_waitcnt lgkmcnt(0)
  s_branch LA_pe0
LA_fallback:
  s_waitcnt vmcnt(0) lgkmcnt(0)
  v_lshrrev_b32 v7, 4, v1
  s_and_b32 s44, s40, 1
  s_lshl_b32 s44, s44, 1
LF_pass:
  v_mov_b32 v96, 0xff800000
  v_mov_b32 v97, 0
  v_mov_b32 v32, 0
  v_mov_b32 v33, 0
  v_mov_b32 v34, 0
  v_mov_b32 v35, 0
  v_mov_b32 v36, 0
  v_mov_b32 v37, 0
  v_mov_b32 v38, 0
  v_mov_b32 v39, 0
  v_mov_b32 v40, 0
  v_mov_b32 v41, 0
  v_mov_b32 v42, 0
  v_mov_b32 v43, 0
  v_mov_b32 v44, 0
  v_mov_b32 v45, 0
  v_mov_b32 v46, 0
  v_mov_b32 v47, 0
  v_lshrrev_b32 v103, 5, v7
  v_lshlrev_b32 v102, 3, v103
  v_lshlrev_b32 v101, 11, v103
  v_lshlrev_b32 v105, 4, v103
  v_and_b32 v103, 31, v7
  v_lshl_add_u32 v101, v103, 2, v101
  s_lshl_b32 s50, s44, 7
  v_add_u32 v101, s50, v101
  v_lshl_add_u32 v105, v103, 8, v105
  v_lshlrev_b32 v104, 1, v105
  v_lshlrev_b32 v106, 1, v103
  s_mov_b32 s47, 0
LF_loop:
  s_lshl_b32 s45, s42, 6
  s_add_u32 s45, s45, s47
  s_lshl_b32 s46, s45, 6
  s_lshl_b32 s45, s45, 14
  s_mov_b32 s50, s45
  s_mov_b32 s60, s12
  s_mov_b32 s61, s13
  s_mov_b32 s62, 4194304
  s_mov_b32 s63, 0x20000
  buffer_load_dword v64, v101, s[60:63], s50 offen offset:0
  buffer_load_dword v65, v101, s[60:63], s50 offen offset:512
  buffer_load_dword v66, v101, s[60:63], s50 offen offset:1024
  buffer_load_dword v67, v101, s[60:63], s50 offen offset:1536
  s_add_u32 s50, s50, 4096
  buffer_load_dword v68, v101, s[60:63], s50 offen offset:0
  buffer_load_dword v69, v101, s[60:63], s50 offen offset:512
  buffer_load_dword v70, v101, s[60:63], s50 offen offset:1024
  buffer_load_dword v71, v101, s[60:63], s50 offen offset:1536
  s_add_u32 s50, s50, 4096
  buffer_load_dword v72, v101, s[60:63], s50 offen offset:0
  buffer_load_dword v73, v101, s[60:63], s50 offen offset:512
  buffer_load_dword v74, v101, s[60:63], s50 offen offset:1024
  buffer_load_dword v75, v101, s[60:63], s50 offen offset:1536
  s_add_u32 s50, s50, 4096
  buffer_load_dword v76, v101, s[60:63], s50 offen offset:0
  buffer_load_dword v77, v101, s[60:63], s50 offen offset:512
  buffer_load_dword v78, v101, s[60:63], s50 offen offset:1024
  buffer_load_dword v79, v101, s[60:63], s50 offen offset:1536
  s_add_u32 s50, s50, 4096
  s_mov_b32 s64, s14
  s_mov_b32 s65, s15
  s_mov_b32 s66, 16384
  s_mov_b32 s67, 0x20000
  s_mov_b32 s68, s16
  s_mov_b32 s69, s17
  s_mov_b32 s70, 16384
  s_mov_b32 s71, 0x20000
  buffer_load_dwordx2 v[88:89], v102, s[64:67], s46 offen offset:0
  buffer_load_dwordx2 v[80:81], v102, s[68:71], s46 offen offset:0
  buffer_load_dwordx2 v[90:91], v102, s[64:67], s46 offen offset:16
  buffer_load_dwordx2 v[82:83], v102, s[68:71], s46 offen offset:16
  buffer_load_dwordx2 v[92:93], v102, s[64:67], s46 offen offset:32
  buffer_load_dwordx2 v[84:85], v102, s[68:71], s46 offen offset:32
  buffer_load_dwordx2 v[94:95], v102, s[64:67], s46 offen offset:48
  buffer_load_dwordx2 v[86:87], v102, s[68:71], s46 offen offset:48
  s_mov_b32 s60, s8
  s_mov_b32 s61, s9
  s_mov_b32 s62, 16384
  s_mov_b32 s63, 0x20000
  s_mov_b32 s64, s10
  s_mov_b32 s65, s11
  s_mov_b32 s66, 16384
  s_mov_b32 s67, 0x20000
  buffer_load_ushort v108, v106, s[60:63], s46 offen
  buffer_load_ushort v109, v106, s[64:67], s46 offen
  v_mov_b32 v16, 0
  v_mov_b32 v17, 0
  v_mov_b32 v18, 0
  v_mov_b32 v19, 0
  v_mov_b32 v20, 0
  v_mov_b32 v21, 0
  v_mov_b32 v22, 0
  v_mov_b32 v23, 0
  v_mov_b32 v24, 0
  v_mov_b32 v25, 0
  v_mov_b32 v26, 0
  v_mov_b32 v27, 0
  v_mov_b32 v28, 0
  v_mov_b32 v29, 0
  v_mov_b32 v30, 0
  v_mov_b32 v31, 0
  s_mov_b32 s60, s6
  s_mov_b32 s61, s7
  s_mov_b32 s62, 4194304
  s_mov_b32 s63, 0x20000
  s_mov_b32 s64, s22
  s_mov_b32 s65, s23
  s_mov_b32 s66, 524288
  s_mov_b32 s67, 0x20000
  s_mov_b32 s68, s24
  s_mov_b32 s69, s25
  s_mov_b32 s70, 524288
  s_mov_b32 s71, 0x20000
  s_lshl_b32 s46, s47, 13
  v_mul_u32_u24 v107, 2, v102
  v_add_u32 v107, v107, v1
  v_add_u32 v107, 123648, v107
  s_mov_b32 s50, 0
LF_step:
  buffer_load_dwordx4 v[128:131], v104, s[60:63], s45 offen offset:0
  buffer_load_dwordx4 v[132:135], v104, s[60:63], s45 offen offset:16
  buffer_load_dwordx4 v[136:139], v104, s[60:63], s45 offen offset:256
  buffer_load_dwordx4 v[140:143], v104, s[60:63], s45 offen offset:272
  buffer_load_dwordx4 v[144:147], v105, s[64:67], s46 offen
  buffer_load_dwordx4 v[148:151], v105, s[64:67], s46 offen offset:128
  buffer_load_dwordx4 v[152:155], v105, s[68:71], s46 offen
  buffer_load_dwordx4 v[156:159], v105, s[68:71], s46 offen offset:128
  ds_read_b128 v[112:115], v107
  ds_read_b128 v[116:119], v107 offset:4224
  s_waitcnt vmcnt(0) lgkmcnt(0)
  v_mov_b32 v110, v108
  v_mov_b32 v111, v109
  v_lshlrev_b32 v110, 16, v110
  v_lshlrev_b32 v111, 16, v111
  v_cvt_f32_i32 v128, v128
  v_cvt_f32_i32 v129, v129
  v_cvt_f32_i32 v130, v130
  v_cvt_f32_i32 v131, v131
  v_cvt_f32_i32 v132, v132
  v_cvt_f32_i32 v133, v133
  v_cvt_f32_i32 v134, v134
  v_cvt_f32_i32 v135, v135
  v_cvt_f32_i32 v136, v136
  v_cvt_f32_i32 v137, v137
  v_cvt_f32_i32 v138, v138
  v_cvt_f32_i32 v139, v139
  v_cvt_f32_i32 v140, v140
  v_cvt_f32_i32 v141, v141
  v_cvt_f32_i32 v142, v142
  v_cvt_f32_i32 v143, v143
  v_mul_f32 v111, v111, v110
  v_fma_f32 v128, v128, v110, -v111
  v_fma_f32 v129, v129, v110, -v111
  v_fma_f32 v130, v130, v110, -v111
  v_fma_f32 v131, v131, v110, -v111
  v_fma_f32 v132, v132, v110, -v111
  v_fma_f32 v133, v133, v110, -v111
  v_fma_f32 v134, v134, v110, -v111
  v_fma_f32 v135, v135, v110, -v111
  v_fma_f32 v136, v136, v110, -v111
  v_fma_f32 v137, v137, v110, -v111
  v_fma_f32 v138, v138, v110, -v111
  v_fma_f32 v139, v139, v110, -v111
  v_fma_f32 v140, v140, v110, -v111
  v_fma_f32 v141, v141, v110, -v111
  v_fma_f32 v142, v142, v110, -v111
  v_fma_f32 v143, v143, v110, -v111
  v_lshlrev_b32 v160, 16, v144
  v_lshlrev_b32 v161, 16, v152
  v_lshlrev_b32 v162, 16, v148
  v_lshlrev_b32 v163, 16, v156
  v_mul_f32 v164, v128, v160
  v_mul_f32 v166, v136, v162
  v_fma_f32 v164, -v136, v161, v164
  v_fmac_f32 v166, v128, v163
  v_and_b32 v160, 0xffff0000, v144
  v_and_b32 v161, 0xffff0000, v152
  v_and_b32 v162, 0xffff0000, v148
  v_and_b32 v163, 0xffff0000, v156
  v_mul_f32 v165, v129, v160
  v_mul_f32 v167, v137, v162
  v_fma_f32 v165, -v137, v161, v165
  v_fmac_f32 v167, v129, v163
  v_cvt_pk_bf16_f32 v168, v164, v165
  v_cvt_pk_bf16_f32 v172, v166, v167
  v_lshlrev_b32 v160, 16, v145
  v_lshlrev_b32 v161, 16, v153
  v_lshlrev_b32 v162, 16, v149
  v_lshlrev_b32 v163, 16, v157
  v_mul_f32 v164, v130, v160
  v_mul_f32 v166, v138, v162
  v_fma_f32 v164, -v138, v161, v164
  v_fmac_f32 v166, v130, v163
  v_and_b32 v160, 0xffff0000, v145
  v_and_b32 v161, 0xffff0000, v153
  v_and_b32 v162, 0xffff0000, v149
  v_and_b32 v163, 0xffff0000, v157
  v_mul_f32 v165, v131, v160
  v_mul_f32 v167, v139, v162
  v_fma_f32 v165, -v139, v161, v165
  v_fmac_f32 v167, v131, v163
  v_cvt_pk_bf16_f32 v169, v164, v165
  v_cvt_pk_bf16_f32 v173, v166, v167
  v_lshlrev_b32 v160, 16, v146
  v_lshlrev_b32 v161, 16, v154
  v_lshlrev_b32 v162, 16, v150
  v_lshlrev_b32 v163, 16, v158
  v_mul_f32 v164, v132, v160
  v_mul_f32 v166, v140, v162
  v_fma_f32 v164, -v140, v161, v164
  v_fmac_f32 v166, v132, v163
  v_and_b32 v160, 0xffff0000, v146
  v_and_b32 v161, 0xffff0000, v154
  v_and_b32 v162, 0xffff0000, v150
  v_and_b32 v163, 0xffff0000, v158
  v_mul_f32 v165, v133, v160
  v_mul_f32 v167, v141, v162
  v_fma_f32 v165, -v141, v161, v165
  v_fmac_f32 v167, v133, v163
  v_cvt_pk_bf16_f32 v170, v164, v165
  v_cvt_pk_bf16_f32 v174, v166, v167
  v_lshlrev_b32 v160, 16, v147
  v_lshlrev_b32 v161, 16, v155
  v_lshlrev_b32 v162, 16, v151
  v_lshlrev_b32 v163, 16, v159
  v_mul_f32 v164, v134, v160
  v_mul_f32 v166, v142, v162
  v_fma_f32 v164, -v142, v161, v164
  v_fmac_f32 v166, v134, v163
  v_and_b32 v160, 0xffff0000, v147
  v_and_b32 v161, 0xffff0000, v155
  v_and_b32 v162, 0xffff0000, v151
  v_and_b32 v163, 0xffff0000, v159
  v_mul_f32 v165, v135, v160
  v_mul_f32 v167, v143, v162
  v_fma_f32 v165, -v143, v161, v165
  v_fmac_f32 v167, v135, v163
  v_cvt_pk_bf16_f32 v171, v164, v165
  v_cvt_pk_bf16_f32 v175, v166, v167
  s_add_u32 s45, s45, 64
  s_add_u32 s46, s46, 32
  v_mfma_f32_32x32x16_bf16 v[16:31], v[168:171], v[112:115], v[16:31]
  v_mfma_f32_32x32x16_bf16 v[16:31], v[172:175], v[116:119], v[16:31]
  v_add_u32 v107, 1056, v107
  s_add_u32 s50, s50, 1
  s_nop 7
  s_cmp_lt_u32 s50, 4
  s_cbranch_scc1 LF_step
  v_cvt_f32_i32 v64, v64
  v_lshlrev_b32 v98, 16, v80
  v_lshlrev_b32 v99, 16, v88
  v_sub_f32 v64, v64, v98
  v_mul_f32 v64, v64, v99
  v_cvt_f32_i32 v65, v65
  v_and_b32 v98, 0xffff0000, v80
  v_and_b32 v99, 0xffff0000, v88
  v_sub_f32 v65, v65, v98
  v_mul_f32 v65, v65, v99
  v_cvt_f32_i32 v66, v66
  v_lshlrev_b32 v98, 16, v81
  v_lshlrev_b32 v99, 16, v89
  v_sub_f32 v66, v66, v98
  v_mul_f32 v66, v66, v99
  v_cvt_f32_i32 v67, v67
  v_and_b32 v98, 0xffff0000, v81
  v_and_b32 v99, 0xffff0000, v89
  v_sub_f32 v67, v67, v98
  v_mul_f32 v67, v67, v99
  v_cvt_f32_i32 v68, v68
  v_lshlrev_b32 v98, 16, v82
  v_lshlrev_b32 v99, 16, v90
  v_sub_f32 v68, v68, v98
  v_mul_f32 v68, v68, v99
  v_cvt_f32_i32 v69, v69
  v_and_b32 v98, 0xffff0000, v82
  v_and_b32 v99, 0xffff0000, v90
  v_sub_f32 v69, v69, v98
  v_mul_f32 v69, v69, v99
  v_cvt_f32_i32 v70, v70
  v_lshlrev_b32 v98, 16, v83
  v_lshlrev_b32 v99, 16, v91
  v_sub_f32 v70, v70, v98
  v_mul_f32 v70, v70, v99
  v_cvt_f32_i32 v71, v71
  v_and_b32 v98, 0xffff0000, v83
  v_and_b32 v99, 0xffff0000, v91
  v_sub_f32 v71, v71, v98
  v_mul_f32 v71, v71, v99
  v_cvt_f32_i32 v72, v72
  v_lshlrev_b32 v98, 16, v84
  v_lshlrev_b32 v99, 16, v92
  v_sub_f32 v72, v72, v98
  v_mul_f32 v72, v72, v99
  v_cvt_f32_i32 v73, v73
  v_and_b32 v98, 0xffff0000, v84
  v_and_b32 v99, 0xffff0000, v92
  v_sub_f32 v73, v73, v98
  v_mul_f32 v73, v73, v99
  v_cvt_f32_i32 v74, v74
  v_lshlrev_b32 v98, 16, v85
  v_lshlrev_b32 v99, 16, v93
  v_sub_f32 v74, v74, v98
  v_mul_f32 v74, v74, v99
  v_cvt_f32_i32 v75, v75
  v_and_b32 v98, 0xffff0000, v85
  v_and_b32 v99, 0xffff0000, v93
  v_sub_f32 v75, v75, v98
  v_mul_f32 v75, v75, v99
  v_cvt_f32_i32 v76, v76
  v_lshlrev_b32 v98, 16, v86
  v_lshlrev_b32 v99, 16, v94
  v_sub_f32 v76, v76, v98
  v_mul_f32 v76, v76, v99
  v_cvt_f32_i32 v77, v77
  v_and_b32 v98, 0xffff0000, v86
  v_and_b32 v99, 0xffff0000, v94
  v_sub_f32 v77, v77, v98
  v_mul_f32 v77, v77, v99
  v_cvt_f32_i32 v78, v78
  v_lshlrev_b32 v98, 16, v87
  v_lshlrev_b32 v99, 16, v95
  v_sub_f32 v78, v78, v98
  v_mul_f32 v78, v78, v99
  v_cvt_f32_i32 v79, v79
  v_and_b32 v98, 0xffff0000, v87
  v_and_b32 v99, 0xffff0000, v95
  v_sub_f32 v79, v79, v98
  v_mul_f32 v79, v79, v99
  v_cvt_pk_bf16_f32 v56, v64, v65
  v_cvt_pk_bf16_f32 v57, v66, v67
  v_cvt_pk_bf16_f32 v58, v68, v69
  v_cvt_pk_bf16_f32 v59, v70, v71
  v_cvt_pk_bf16_f32 v60, v72, v73
  v_cvt_pk_bf16_f32 v61, v74, v75
  v_cvt_pk_bf16_f32 v62, v76, v77
  v_cvt_pk_bf16_f32 v63, v78, v79
  v_max3_f32 v98, v16, v17, v96
  v_max3_f32 v98, v18, v19, v98
  v_max3_f32 v98, v20, v21, v98
  v_max3_f32 v98, v22, v23, v98
  v_max3_f32 v98, v24, v25, v98
  v_max3_f32 v98, v26, v27, v98
  v_max3_f32 v98, v28, v29, v98
  v_max3_f32 v98, v30, v31, v98
  v_mov_b32 v99, v98
  s_nop 1
  v_permlane32_swap_b32 v98, v99
  s_nop 1
  v_max_f32 v98, v98, v99
  v_sub_f32 v100, v96, v98
  v_exp_f32 v100, v100
  v_mov_b32 v96, v98
  v_mul_f32 v97, v97, v100
  v_mul_f32 v32, v32, v100
  v_mul_f32 v33, v33, v100
  v_mul_f32 v34, v34, v100
  v_mul_f32 v35, v35, v100
  v_mul_f32 v36, v36, v100
  v_mul_f32 v37, v37, v100
  v_mul_f32 v38, v38, v100
  v_mul_f32 v39, v39, v100
  v_mul_f32 v40, v40, v100
  v_mul_f32 v41, v41, v100
  v_mul_f32 v42, v42, v100
  v_mul_f32 v43, v43, v100
  v_mul_f32 v44, v44, v100
  v_mul_f32 v45, v45, v100
  v_mul_f32 v46, v46, v100
  v_mul_f32 v47, v47, v100
  v_sub_f32 v16, v16, v96
  v_sub_f32 v17, v17, v96
  v_sub_f32 v18, v18, v96
  v_sub_f32 v19, v19, v96
  v_sub_f32 v20, v20, v96
  v_sub_f32 v21, v21, v96
  v_sub_f32 v22, v22, v96
  v_sub_f32 v23, v23, v96
  v_sub_f32 v24, v24, v96
  v_sub_f32 v25, v25, v96
  v_sub_f32 v26, v26, v96
  v_sub_f32 v27, v27, v96
  v_sub_f32 v28, v28, v96
  v_sub_f32 v29, v29, v96
  v_sub_f32 v30, v30, v96
  v_sub_f32 v31, v31, v96
  v_exp_f32 v16, v16
  v_exp_f32 v17, v17
  v_exp_f32 v18, v18
  v_exp_f32 v19, v19
  v_exp_f32 v20, v20
  v_exp_f32 v21, v21
  v_exp_f32 v22, v22
  v_exp_f32 v23, v23
  v_exp_f32 v24, v24
  v_exp_f32 v25, v25
  v_exp_f32 v26, v26
  v_exp_f32 v27, v27
  v_exp_f32 v28, v28
  v_exp_f32 v29, v29
  v_exp_f32 v30, v30
  v_exp_f32 v31, v31
  s_nop 0
  v_add_f32 v97, v97, v16
  v_add_f32 v97, v97, v17
  v_add_f32 v97, v97, v18
  v_add_f32 v97, v97, v19
  v_add_f32 v97, v97, v20
  v_add_f32 v97, v97, v21
  v_add_f32 v97, v97, v22
  v_add_f32 v97, v97, v23
  v_add_f32 v97, v97, v24
  v_add_f32 v97, v97, v25
  v_add_f32 v97, v97, v26
  v_add_f32 v97, v97, v27
  v_add_f32 v97, v97, v28
  v_add_f32 v97, v97, v29
  v_add_f32 v97, v97, v30
  v_add_f32 v97, v97, v31
  v_cvt_pk_bf16_f32 v48, v16, v17
  v_cvt_pk_bf16_f32 v49, v18, v19
  v_cvt_pk_bf16_f32 v50, v20, v21
  v_cvt_pk_bf16_f32 v51, v22, v23
  v_cvt_pk_bf16_f32 v52, v24, v25
  v_cvt_pk_bf16_f32 v53, v26, v27
  v_cvt_pk_bf16_f32 v54, v28, v29
  v_cvt_pk_bf16_f32 v55, v30, v31
  s_nop 1
  v_mfma_f32_32x32x16_bf16 v[32:47], v[56:59], v[48:51], v[32:47]
  v_mfma_f32_32x32x16_bf16 v[32:47], v[60:63], v[52:55], v[32:47]
  s_add_u32 s47, s47, 1
  s_cmp_lt_u32 s47, 64
  s_cbranch_scc1 LF_loop
  v_mov_b32 v99, v97
  s_nop 1
  v_permlane32_swap_b32 v97, v99
  s_nop 1
  v_add_f32 v97, v97, v99
  v_rcp_f32 v97, v97
  v_lshrrev_b32 v98, 4, v103
  s_lshr_b32 s50, s40, 1
  v_cmp_eq_u32 vcc, s50, v98
  v_lshlrev_b32 v103, 8, v103
  v_add_u32 v103, v103, v102
  s_lshl_b32 s50, s44, 6
  s_add_u32 s50, s50, s3
  s_nop 3
  v_mul_f32 v32, v32, v97
  v_mul_f32 v33, v33, v97
  v_mul_f32 v34, v34, v97
  v_mul_f32 v35, v35, v97
  v_mul_f32 v36, v36, v97
  v_mul_f32 v37, v37, v97
  v_mul_f32 v38, v38, v97
  v_mul_f32 v39, v39, v97
  v_mul_f32 v40, v40, v97
  v_mul_f32 v41, v41, v97
  v_mul_f32 v42, v42, v97
  v_mul_f32 v43, v43, v97
  v_mul_f32 v44, v44, v97
  v_mul_f32 v45, v45, v97
  v_mul_f32 v46, v46, v97
  v_mul_f32 v47, v47, v97
  v_cvt_pk_bf16_f32 v48, v32, v33
  v_cvt_pk_bf16_f32 v49, v34, v35
  v_cvt_pk_bf16_f32 v50, v36, v37
  v_cvt_pk_bf16_f32 v51, v38, v39
  v_cvt_pk_bf16_f32 v52, v40, v41
  v_cvt_pk_bf16_f32 v53, v42, v43
  v_cvt_pk_bf16_f32 v54, v44, v45
  v_cvt_pk_bf16_f32 v55, v46, v47
  s_mov_b64 exec, vcc
  buffer_store_dwordx2 v[48:49], v103, s[36:39], s50 offen offset:0
  buffer_store_dwordx2 v[50:51], v103, s[36:39], s50 offen offset:16
  buffer_store_dwordx2 v[52:53], v103, s[36:39], s50 offen offset:32
  buffer_store_dwordx2 v[54:55], v103, s[36:39], s50 offen offset:48
  s_mov_b64 exec, -1
  s_add_u32 s44, s44, 1
  s_bitcmp1_b32 s44, 0
  s_cbranch_scc1 LF_pass
  s_endpgm
.section .rodata,"a"
.p2align 6
.amdhsa_kernel standalone__kv_cache_quant_pre_rope_vs_post_rope__prompt_kernel
  .amdhsa_next_free_vgpr 512
  .amdhsa_next_free_sgpr 84
  .amdhsa_accum_offset 256
  .amdhsa_group_segment_fixed_size 0
  .amdhsa_kernarg_size 112
  .amdhsa_user_sgpr_count 2
  .amdhsa_user_sgpr_kernarg_segment_ptr 1
  .amdhsa_system_sgpr_workgroup_id_x 1
  .amdhsa_float_denorm_mode_32 3
  .amdhsa_float_denorm_mode_16_64 3
.end_amdhsa_kernel
```
